```python
import torch

def _softmax(x, axis=-1):
    return torch.softmax(x, dim=axis)
def _gelu(x):
    return torch.nn.functional.gelu(x, approximate="tanh")
def _silu(x):
    return torch.nn.functional.silu(x)
def _sigmoid(x):
    return torch.sigmoid(x)
def _layernorm(x, axis=-1, eps=1e-5):
    m = x.mean(dim=axis, keepdim=True)
    v = x.var(dim=axis, keepdim=True, unbiased=False)
    return (x - m) / torch.sqrt(v + eps)
def _scatter_add(tgt, idx, src, axis=0):
    return tgt.clone().index_add_(axis, idx, src)
def _segment_sum(src, seg, n):
    out = torch.zeros((n,) + src.shape[1:], dtype=src.dtype)
    return out.index_add_(0, seg, src)
def _pad(x, pw):
    flat = tuple(v for pair in reversed(pw) for v in pair)
    return torch.nn.functional.pad(x, flat)

kernel_name = 'interleave_layers__ssm_conv_h3__geglu_ffn__prompt'

def setup_inputs():

    _w = (lambda a: (lambda t: t.to(torch.bfloat16) if t.is_floating_point() else t)(torch.as_tensor(a)))
    def _A_setup():
        B, S, D = 1, 2048, 640
        ks = 4
        return {
            "q": _w((lambda *s: torch.randn(*s, dtype=torch.bfloat16) * 0.05)(B, S, D)),
            "k": _w((lambda *s: torch.randn(*s, dtype=torch.bfloat16) * 1.6)(B, S, D)),
            "v": _w((lambda *s: torch.randn(*s, dtype=torch.bfloat16) * 1.6)(B, S, D)),
            "shift_k": _w((lambda *s: torch.randn(*s, dtype=torch.bfloat16) * 1.6)(D, ks) * 0.5),
            "ssm_k": _w((lambda *s: torch.randn(*s, dtype=torch.bfloat16) * 1.6)(D, S) * (1.0 / S ** 0.5)),
            "ssm_D": _w((lambda *s: torch.randn(*s, dtype=torch.bfloat16) * 1.6)(D)),
        }
    _A_in = _A_setup()

    def _B_setup():
        B, S, D, F = 1, 2048, 640, 1728
        return {
            "x": _w((lambda *s: torch.randn(*s, dtype=torch.bfloat16) * 0.05)(B, S, D)),
            "w_gate": _w((lambda *s: torch.randn(*s, dtype=torch.bfloat16) * 0.2)(D, F)),
            "w_up": _w((lambda *s: torch.randn(*s, dtype=torch.bfloat16) * 0.2)(D, F)),
            "w_down": _w((lambda *s: torch.randn(*s, dtype=torch.bfloat16) * 0.2)(F, D)),
        }
    _B_in = _B_setup()

    return {
        "A_q": _A_in["q"],
        "A_k": _A_in["k"],
        "A_v": _A_in["v"],
        "A_shift_k": _A_in["shift_k"],
        "A_ssm_k": _A_in["ssm_k"],
        "A_ssm_D": _A_in["ssm_D"],
        "B_x": _B_in["x"],
        "B_w_gate": _B_in["w_gate"],
        "B_w_up": _B_in["w_up"],
        "B_w_down": _B_in["w_down"],
    }

def reference(A_q, A_k, A_v, A_shift_k, A_ssm_k, A_ssm_D, B_x, B_w_gate, B_w_up, B_w_down):
    def _A_ref(q, k, v, shift_k, ssm_k, ssm_D):
        B, S, D = q.shape
        ks = shift_k.shape[-1]
        k_pad = _pad(k, ((0, 0), (ks - 1, 0), (0, 0)))
        k_shift = torch.zeros_like(k)
        for t in range(ks):
            k_shift = k_shift + k_pad[:, t:t + S, :] * shift_k[:, ks - 1 - t][None, None, :]
        kv = k_shift * v
        L = 2 * S
        kv_pad = _pad(kv, ((0, 0), (0, S), (0, 0)))
        kf_pad = _pad(ssm_k, ((0, 0), (0, S)))
        kv_f = (lambda x, axes=(-2,-1): torch.fft.rfft2(x.float(), dim=axes))(kv_pad[:, None, :, :], axes=(1, 2))
        kf_f = (lambda x, axes=(-2,-1): torch.fft.rfft2(x.float(), dim=axes))(kf_pad[:, None, :], axes=(1, 2))
        kf_f = (lambda x, *d: x.permute(*d))(kf_f, 1, 2, 0)
        y_f = kv_f * kf_f[None, :, :, :]
        y = (lambda x, s, axes=(-2,-1): torch.fft.irfft2(x, s=s, dim=axes).to(torch.bfloat16))(y_f, (1, L), axes=(1, 2))[:, 0, :S, :]
        y = y + kv * ssm_D[None, None, :]
        return q * y

    def _B_ref(x, w_gate, w_up, w_down):
        return (_gelu(x @ w_gate) * (x @ w_up)) @ w_down

    x = A_q
    x = x + _A_ref(_layernorm(x, axis=-1), A_k, A_v, A_shift_k, A_ssm_k, A_ssm_D)
    x = x + _B_ref(_layernorm(x, axis=-1), B_w_gate, B_w_up, B_w_down)
    x = x + _A_ref(_layernorm(x, axis=-1), A_k, A_v, A_shift_k, A_ssm_k, A_ssm_D)
    x = x + _B_ref(_layernorm(x, axis=-1), B_w_gate, B_w_up, B_w_down)
    return x
```

```asm
; @launch grid=(256,1,1) block=(256,1,1) lds=163840
.amdgcn_target "amdgcn-amd-amdhsa--gfx950"
.text
.globl interleave_layers__ssm_conv_h3__geglu_ffn__prompt_kernel
.p2align 8
.type interleave_layers__ssm_conv_h3__geglu_ffn__prompt_kernel,@function
interleave_layers__ssm_conv_h3__geglu_ffn__prompt_kernel:
    s_cmp_ge_u32 s2, 256
    s_cbranch_scc1 EXIT
    s_load_dwordx2 s[4:5], s[0:1], 8
    s_load_dwordx2 s[8:9], s[0:1], 16
    s_load_dwordx2 s[12:13], s[0:1], 24
    s_load_dwordx2 s[44:45], s[0:1], 96
    s_load_dwordx2 s[16:17], s[0:1], 32
    s_load_dwordx2 s[20:21], s[0:1], 40
    s_load_dwordx2 s[24:25], s[0:1], 0
    s_load_dwordx2 s[28:29], s[0:1], 56
    s_load_dwordx2 s[32:33], s[0:1], 64
    s_load_dwordx2 s[36:37], s[0:1], 72
    s_load_dwordx2 s[40:41], s[0:1], 80
    v_lshrrev_b32 v1, 6, v0
    v_and_b32 v0, 63, v0
    v_readfirstlane_b32 s49, v1
    s_and_b32 s50, s2, 7
    s_lshr_b32 s51, s2, 3
    s_mov_b32 s6, 2621440
    s_mov_b32 s7, 0x00020000
    s_mov_b32 s10, 2621440
    s_mov_b32 s11, 0x00020000
    s_mov_b32 s14, 5120
    s_mov_b32 s15, 0x00020000
    s_mov_b32 s18, 2621440
    s_mov_b32 s19, 0x00020000
    s_mov_b32 s22, 1280
    s_mov_b32 s23, 0x00020000
    s_mov_b32 s26, 2621440
    s_mov_b32 s27, 0x00020000
    s_mov_b32 s30, 2211840
    s_mov_b32 s31, 0x00020000
    s_mov_b32 s34, 2211840
    s_mov_b32 s35, 0x00020000
    s_mov_b32 s38, 2211840
    s_mov_b32 s39, 0x00020000
    s_mov_b32 s42, 2621440
    s_mov_b32 s43, 0x00020000
    s_mov_b32 s46, 41943040
    s_mov_b32 s47, 0x00020000
    v_lshlrev_b32 v1, 4, v0
    v_mul_u32_u24 v16, 205, v0
    v_lshrrev_b32 v16, 11, v16
    v_mul_u32_u24 v17, 10, v16
    v_sub_u32 v17, v0, v17
    s_lshr_b32 s86, s51, 3
    s_add_u32 s86, s86, 1
    s_and_b32 s86, s86, 3
    s_lshl_b32 s87, s50, 2
    s_add_u32 s52, s87, s86
    s_and_b32 s53, s51, 7
    s_lshl_b32 s86, s52, 6
    s_lshl_b32 s87, s49, 4
    s_add_u32 s86, s86, s87
    v_lshlrev_b32 v18, 2, v16
    v_add_u32 v18, s86, v18
    s_mul_i32 s88, s53, 160
    v_mul_u32_u24 v19, 1280, v18
    v_lshl_add_u32 v19, v17, 4, v19
    v_add_u32 v19, s88, v19
    v_subrev_u32 v20, 3840, v19
    v_cmp_eq_u32 vcc, 0, v18
    v_mov_b32 v21, 0x40000000
    s_mul_i32 s88, s53, 640
    v_cndmask_b32 v20, v20, v21, vcc
    v_lshlrev_b32 v21, 6, v17
    v_add_u32 v21, s88, v21
    s_waitcnt lgkmcnt(0)
    s_load_dword s48, s[44:45], 0
    s_mov_b32 exec_lo, -1
    s_mov_b32 exec_hi, 0xff
    buffer_load_dwordx4 v[72:75], v20, s[4:7], 0 offen offset:0
    buffer_load_dwordx4 v[76:79], v20, s[4:7], 0 offen offset:1280
    buffer_load_dwordx4 v[80:83], v20, s[4:7], 0 offen offset:2560
    buffer_load_dwordx4 v[84:87], v19, s[4:7], 0 offen offset:0
    buffer_load_dwordx4 v[88:91], v19, s[4:7], 0 offen offset:1280
    buffer_load_dwordx4 v[92:95], v19, s[4:7], 0 offen offset:2560
    buffer_load_dwordx4 v[96:99], v19, s[4:7], 0 offen offset:3840
    buffer_load_dwordx4 v[100:103], v19, s[8:11], 0 offen offset:0
    buffer_load_dwordx4 v[104:107], v19, s[8:11], 0 offen offset:1280
    buffer_load_dwordx4 v[108:111], v19, s[8:11], 0 offen offset:2560
    buffer_load_dwordx4 v[112:115], v19, s[8:11], 0 offen offset:3840
    buffer_load_dwordx4 v[116:119], v21, s[12:15], 0 offen offset:0
    buffer_load_dwordx4 v[120:123], v21, s[12:15], 0 offen offset:16
    buffer_load_dwordx4 v[124:127], v21, s[12:15], 0 offen offset:32
    buffer_load_dwordx4 v[128:131], v21, s[12:15], 0 offen offset:48
    s_mov_b64 exec, -1
    s_and_b32 s86, s50, 1
    s_lshl_b32 s86, s86, 2
    s_and_b32 s87, s51, 3
    s_add_u32 s54, s86, s87
    s_lshr_b32 s86, s50, 1
    s_mul_i32 s86, s86, 7
    s_lshr_b32 s87, s51, 2
    s_add_u32 s55, s86, s87
    s_mov_b32 s98, 0
    s_cmp_lt_u32 s55, 27
    s_cselect_b32 s98, 1, 0
    s_cmp_lt_u32 s51, 20
    s_cselect_b32 s86, 2, 0
    s_or_b32 s98, s98, s86
    s_cmp_ge_u32 s51, 28
    s_cselect_b32 s98, 4, s98
    s_mov_b32 s56, s44
    s_mov_b32 s57, s45
    s_mov_b32 s58, 41943040
    s_mov_b32 s59, 0x00020000
    s_mov_b32 s60, s44
    s_mov_b32 s61, s45
    s_mov_b32 s62, 0
    s_mov_b32 s63, 0x00020000
    s_bitcmp1_b32 s49, 0
    s_cselect_b32 s64, s32, s28
    s_cselect_b32 s65, s33, s29
    s_mov_b32 s66, 2211840
    s_mov_b32 s67, 0x00020000
    s_mul_i32 s82, s49, 10240
    s_mul_i32 s83, s49, 15104
    s_add_u32 s83, s83, 81920
    s_mov_b32 s28, s44
    s_mov_b32 s29, s45
    s_cmp_eq_u32 s49, 3
    s_cselect_b32 s30, 0, 41943040
    s_cselect_b32 s33, 1, 2
    s_lshl_b32 s33, s33, 11
    s_sub_u32 s34, 1826816, s33
    s_sub_u32 s86, s51, 20
    s_lshl_b32 s32, s86, 3
    s_add_u32 s32, s32, s50
    s_cmp_lt_u32 s32, 54
    s_cbranch_scc0 NOPREP
    s_or_b32 s98, s98, 8
NOPREP:
    v_lshrrev_b32 v66, 3, v0
    v_bfe_u32 v67, v0, 4, 1
    v_lshlrev_b32 v67, 1, v67
    s_and_b32 s86, s49, 1
    s_lshl_b32 s86, s86, 2
    v_or_b32 v67, s86, v67
    v_and_b32 v68, 7, v0
    v_xor_b32 v67, v67, v68
    v_mul_u32_u24 v66, 3456, v66
    v_lshl_add_u32 v64, v67, 4, v66
    s_lshr_b32 s86, s49, 1
    s_mul_i32 s86, s86, 27648
    s_lshl_b32 s85, s55, 7
    s_add_u32 s85, s85, s86
    v_lshrrev_b32 v66, 4, v0
    v_and_b32 v67, 1, v66
    v_lshrrev_b32 v66, 1, v66
    v_lshlrev_b32 v66, 11, v66
    v_lshl_add_u32 v66, v67, 10, v66
    v_bfe_u32 v68, v0, 2, 2
    v_lshl_add_u32 v66, v68, 7, v66
    v_lshrrev_b32 v68, 1, v68
    v_lshl_add_u32 v68, v67, 1, v68
    v_xor_b32 v68, s49, v68
    v_lshl_add_u32 v66, v68, 5, v66
    v_and_b32 v68, 3, v0
    v_lshl_add_u32 v66, v68, 3, v66
    v_add_u32 v65, 84992, v66
    s_bitcmp1_b32 s98, 3
    s_cbranch_scc0 P0_NOP
    v_add_u32 v22, 0, v0
    v_mul_u32_u24 v23, 3277, v22
    v_lshrrev_b32 v23, 16, v23
    v_mul_u32_u24 v24, 960, v23
    v_lshl_add_u32 v160, v22, 4, v24
    v_add_u32 v22, 64, v0
    v_mul_u32_u24 v23, 3277, v22
    v_lshrrev_b32 v23, 16, v23
    v_mul_u32_u24 v24, 960, v23
    v_lshl_add_u32 v161, v22, 4, v24
    v_add_u32 v22, 128, v0
    v_mul_u32_u24 v23, 3277, v22
    v_lshrrev_b32 v23, 16, v23
    v_mul_u32_u24 v24, 960, v23
    v_lshl_add_u32 v162, v22, 4, v24
    v_add_u32 v22, 192, v0
    v_mul_u32_u24 v23, 3277, v22
    v_lshrrev_b32 v23, 16, v23
    v_mul_u32_u24 v24, 960, v23
    v_lshl_add_u32 v163, v22, 4, v24
    v_add_u32 v22, 256, v0
    v_mul_u32_u24 v23, 3277, v22
    v_lshrrev_b32 v23, 16, v23
    v_mul_u32_u24 v24, 960, v23
    v_lshl_add_u32 v164, v22, 4, v24
    s_mul_i32 s86, s32, 40960
    s_mul_i32 s87, s49, 320
    s_add_u32 s86, s86, s87
    s_add_u32 s87, s86, 20480
    s_mov_b32 m0, s82
    s_nop 0
    buffer_load_dwordx4 v160, s[36:39], s86 offen lds
    s_add_u32 m0, m0, 1024
    s_nop 0
    buffer_load_dwordx4 v161, s[36:39], s86 offen lds
    s_add_u32 m0, m0, 1024
    s_nop 0
    buffer_load_dwordx4 v162, s[36:39], s86 offen lds
    s_add_u32 m0, m0, 1024
    s_nop 0
    buffer_load_dwordx4 v163, s[36:39], s86 offen lds
    s_add_u32 m0, m0, 1024
    s_nop 0
    buffer_load_dwordx4 v164, s[36:39], s86 offen lds
    s_add_u32 m0, m0, 1024
    s_nop 0
    buffer_load_dwordx4 v160, s[36:39], s87 offen lds
    s_add_u32 m0, m0, 1024
    s_nop 0
    buffer_load_dwordx4 v161, s[36:39], s87 offen lds
    s_add_u32 m0, m0, 1024
    s_nop 0
    buffer_load_dwordx4 v162, s[36:39], s87 offen lds
    s_add_u32 m0, m0, 1024
    s_nop 0
    buffer_load_dwordx4 v163, s[36:39], s87 offen lds
    s_add_u32 m0, m0, 1024
    s_nop 0
    buffer_load_dwordx4 v164, s[36:39], s87 offen lds
    s_add_u32 m0, m0, 1024
P0_NOP:
    s_bitcmp1_b32 s98, 1
    s_cbranch_scc0 P0_NOH
    s_mul_i32 s86, s50, 20
    s_add_u32 s86, s86, s51
    s_lshl_b32 s86, s86, 2
    s_add_u32 s86, s86, s49
    s_lshl_b32 s87, s86, 12
    v_add_u32 v38, s87, v1
    v_subrev_u32 v39, 8, v38
    s_lshl_b32 s87, s86, 1
    v_mov_b32 v36, s87
    v_mov_b32 v40, 0
    v_mov_b32 v41, 0
    s_mov_b64 exec, -2
    buffer_load_dwordx2 v[40:41], v39, s[16:19], 0 offen
    s_mov_b64 exec, -1
    buffer_load_dwordx4 v[42:45], v38, s[16:19], 0 offen offset:0
    buffer_load_dwordx2 v[46:47], v39, s[16:19], 0 offen offset:1024
    buffer_load_dwordx4 v[48:51], v38, s[16:19], 0 offen offset:1024
    buffer_load_dwordx2 v[52:53], v39, s[16:19], 0 offen offset:2048
    buffer_load_dwordx4 v[54:57], v38, s[16:19], 0 offen offset:2048
    buffer_load_dwordx2 v[58:59], v39, s[16:19], 0 offen offset:3072
    buffer_load_dwordx4 v[60:63], v38, s[16:19], 0 offen offset:3072
    buffer_load_ushort v37, v36, s[20:23], 0 offen
    s_lshl_b32 s86, s49, 10
    s_add_u32 m0, s86, 84992
    s_nop 0
    buffer_load_dwordx4 v64, s[64:67], s85 offen lds
    s_add_u32 m0, m0, 4096
    s_add_u32 s85, s85, 55296
    buffer_load_dwordx4 v64, s[64:67], s85 offen lds
    s_add_u32 m0, m0, 4096
    s_add_u32 s85, s85, 55296
    buffer_load_dwordx4 v64, s[64:67], s85 offen lds
    s_add_u32 m0, m0, 4096
    s_add_u32 s85, s85, 55296
    buffer_load_dwordx4 v64, s[64:67], s85 offen lds
    s_add_u32 m0, m0, 4096
    s_add_u32 s85, s85, 55296
    buffer_load_dwordx4 v64, s[64:67], s85 offen lds
    s_add_u32 m0, m0, 4096
    s_add_u32 s85, s85, 55296
    buffer_load_dwordx4 v64, s[64:67], s85 offen lds
    s_add_u32 m0, m0, 4096
    s_add_u32 s85, s85, 55296
    buffer_load_dwordx4 v64, s[64:67], s85 offen lds
    s_add_u32 m0, m0, 4096
    s_add_u32 s85, s85, 55296
    buffer_load_dwordx4 v64, s[64:67], s85 offen lds
    s_add_u32 m0, m0, 4096
    s_add_u32 s85, s85, 55296
    buffer_load_dwordx4 v64, s[64:67], s85 offen lds
    s_add_u32 m0, m0, 4096
    s_add_u32 s85, s85, 55296
    buffer_load_dwordx4 v64, s[64:67], s85 offen lds
    s_add_u32 m0, m0, 4096
    s_add_u32 s85, s85, 55296
    buffer_load_dwordx4 v64, s[64:67], s85 offen lds
    s_add_u32 m0, m0, 4096
    s_add_u32 s85, s85, 55296
    buffer_load_dwordx4 v64, s[64:67], s85 offen lds
    s_add_u32 m0, m0, 4096
    s_add_u32 s85, s85, 55296
    buffer_load_dwordx4 v64, s[64:67], s85 offen lds
    s_add_u32 m0, m0, 4096
    s_add_u32 s85, s85, 55296
    buffer_load_dwordx4 v64, s[64:67], s85 offen lds
    s_add_u32 m0, m0, 4096
    s_add_u32 s85, s85, 55296
    buffer_load_dwordx4 v64, s[64:67], s85 offen lds
    s_add_u32 m0, m0, 4096
    s_add_u32 s85, s85, 55296
    buffer_load_dwordx4 v64, s[64:67], s85 offen lds
    s_add_u32 m0, m0, 4096
    s_add_u32 s85, s85, 55296
P0_NOH:
    v_and_b32 v22, 31, v0
    v_lshrrev_b32 v23, 5, v0
    v_lshrrev_b32 v24, 3, v22
    v_mul_u32_u24 v24, 10240, v24
    v_and_b32 v25, 7, v22
    v_lshl_add_u32 v24, v25, 7, v24
    v_bfe_u32 v25, v22, 1, 3
    v_xor_b32 v25, v25, v23
    v_xor_b32 v26, 0, v25
    v_lshl_add_u32 v2, v26, 4, v24
    v_xor_b32 v26, 2, v25
    v_lshl_add_u32 v3, v26, 4, v24
    v_xor_b32 v26, 4, v25
    v_lshl_add_u32 v4, v26, 4, v24
    v_xor_b32 v26, 6, v25
    v_lshl_add_u32 v5, v26, 4, v24
    v_add_u32 v6, 4096, v1
    v_add_u32 v7, s83, v1
    v_lshrrev_b32 v24, 4, v22
    v_mul_u32_u24 v24, 57344, v24
    v_lshl_add_u32 v24, v23, 8, v24
    v_and_b32 v25, 15, v0
    v_lshl_add_u32 v8, v25, 4, v24
    s_cmp_eq_u32 s49, 3
    s_cselect_b32 s86, 23, 27
    v_min_u32 v9, s86, v0
    v_lshlrev_b32 v9, 7, v9
    v_and_b32 v24, 1, v0
    v_bfe_u32 v26, v0, 1, 1
    v_lshl_add_u32 v24, v26, 3, v24
    s_lshl_b32 s86, s54, 2
    s_lshr_b32 s87, s49, 1
    s_add_u32 s86, s86, s87
    s_lshl_b32 s86, s86, 2
    s_and_b32 s87, s49, 1
    s_lshl_b32 s87, s87, 1
    s_add_u32 s86, s86, s87
    v_add_u32 v24, s86, v24
    v_lshlrev_b32 v10, 7, v24
    v_mul_u32_u24 v24, 336, v25
    v_lshrrev_b32 v26, 4, v0
    v_lshl_add_u32 v24, v26, 4, v24
    s_mul_i32 s86, s49, 5376
    s_add_u32 s86, s86, 142336
    v_add_u32 v11, s86, v24
    s_lshl_b32 s86, s49, 2
    v_add_u32 v24, s86, v16
    v_min_u32 v24, 15, v24
    v_mul_u32_u24 v26, 336, v24
    v_lshl_add_u32 v26, v17, 5, v26
    v_add_u32 v12, 142336, v26
    v_mul_u32_u24 v26, 1280, v24
    v_lshl_add_u32 v13, v17, 4, v26
    s_waitcnt lgkmcnt(0)
    s_mul_i32 s48, s48, 0x9E3779B1
    s_add_u32 s48, s48, 0x7F4A7C15
    v_mov_b32 v15, s48
    s_mov_b32 s100, 0x409d30fc
    s_mov_b32 s101, 0x4091afa4
    s_bitcmp1_b32 s98, 1
    s_cbranch_scc1 P0_W25
    s_bitcmp1_b32 s98, 3
    s_cbranch_scc1 P0_W10
    s_waitcnt vmcnt(0)
P0_W10:
    s_waitcnt vmcnt(10)
P0_W25:
    s_waitcnt vmcnt(25)
    s_mov_b32 s88, 0x05040100
    s_mov_b32 s89, 0x07060302
    s_lshl_b32 s86, s49, 1
    v_lshrrev_b32 v22, 1, v16
    v_add_u32 v22, s86, v22
    v_and_b32 v23, 7, v17
    v_xor_b32 v22, v22, v23
    v_lshlrev_b32 v22, 4, v22
    v_and_b32 v23, 1, v16
    v_lshl_add_u32 v22, v23, 3, v22
    v_lshl_add_u32 v22, v17, 10, v22
    v_add_u32 v22, 153600, v22
    v_mov_b32 v28, -1
    v_mov_b32 v29, -1
    v_mov_b32 v30, -1
    v_mov_b32 v31, -1
    s_mul_i32 s86, s52, 20480
    s_mul_i32 s87, s53, 2560
    s_add_u32 s86, s86, s87
    s_mul_i32 s87, s49, 640
    s_add_u32 s86, s86, s87
    s_add_u32 s86, s86, 20578304
    s_mov_b32 s8, s44
    s_mov_b32 s9, s45
    s_mov_b32 exec_lo, -1
    s_mov_b32 exec_hi, 0xff
    buffer_store_dwordx4 v[28:31], v1, s[44:47], s86 offen sc1
    s_add_u32 s86, s86, 655360
    buffer_store_dwordx4 v[28:31], v1, s[44:47], s86 offen sc1
    s_add_u32 s86, s86, 655360
    buffer_store_dwordx4 v[28:31], v1, s[44:47], s86 offen sc1
    s_add_u32 s86, s86, 655360
    buffer_store_dwordx4 v[28:31], v1, s[44:47], s86 offen sc1
    s_add_u32 s86, s86, 655360
    v_perm_b32 v132, v72, v76, s88
    v_perm_b32 v133, v76, v80, s88
    v_perm_b32 v134, v80, v84, s88
    v_perm_b32 v135, v84, v88, s88
    v_perm_b32 v136, v88, v92, s88
    v_perm_b32 v137, v92, v96, s88
    v_dot2_f32_bf16 v138, v132, v117, 0
    v_dot2_f32_bf16 v139, v133, v117, 0
    v_dot2_f32_bf16 v140, v134, v117, 0
    v_dot2_f32_bf16 v141, v135, v117, 0
    v_dot2_f32_bf16 v138, v134, v116, v138
    v_dot2_f32_bf16 v139, v135, v116, v139
    v_dot2_f32_bf16 v140, v136, v116, v140
    v_dot2_f32_bf16 v141, v137, v116, v141
    v_lshlrev_b32 v24, 16, v100
    v_lshlrev_b32 v25, 16, v104
    v_lshlrev_b32 v26, 16, v108
    v_lshlrev_b32 v27, 16, v112
    v_pk_mul_f32 v[138:139], v[138:139], v[24:25]
    v_pk_mul_f32 v[140:141], v[140:141], v[26:27]
    v_cvt_pk_bf16_f32 v142, v138, v139
    v_cvt_pk_bf16_f32 v143, v140, v141
    ds_write_b64 v22, v[142:143] offset:0
    v_perm_b32 v132, v72, v76, s89
    v_perm_b32 v133, v76, v80, s89
    v_perm_b32 v134, v80, v84, s89
    v_perm_b32 v135, v84, v88, s89
    v_perm_b32 v136, v88, v92, s89
    v_perm_b32 v137, v92, v96, s89
    v_dot2_f32_bf16 v144, v132, v119, 0
    v_dot2_f32_bf16 v145, v133, v119, 0
    v_dot2_f32_bf16 v146, v134, v119, 0
    v_dot2_f32_bf16 v147, v135, v119, 0
    v_dot2_f32_bf16 v144, v134, v118, v144
    v_dot2_f32_bf16 v145, v135, v118, v145
    v_dot2_f32_bf16 v146, v136, v118, v146
    v_dot2_f32_bf16 v147, v137, v118, v147
    v_and_b32 v24, 0xffff0000, v100
    v_and_b32 v25, 0xffff0000, v104
    v_and_b32 v26, 0xffff0000, v108
    v_and_b32 v27, 0xffff0000, v112
    v_pk_mul_f32 v[144:145], v[144:145], v[24:25]
    v_pk_mul_f32 v[146:147], v[146:147], v[26:27]
    v_cvt_pk_bf16_f32 v148, v144, v145
    v_cvt_pk_bf16_f32 v149, v146, v147
    ds_write_b64 v22, v[148:149] offset:128
    v_perm_b32 v132, v73, v77, s88
    v_perm_b32 v133, v77, v81, s88
    v_perm_b32 v134, v81, v85, s88
    v_perm_b32 v135, v85, v89, s88
    v_perm_b32 v136, v89, v93, s88
    v_perm_b32 v137, v93, v97, s88
    v_dot2_f32_bf16 v138, v132, v121, 0
    v_dot2_f32_bf16 v139, v133, v121, 0
    v_dot2_f32_bf16 v140, v134, v121, 0
    v_dot2_f32_bf16 v141, v135, v121, 0
    v_dot2_f32_bf16 v138, v134, v120, v138
    v_dot2_f32_bf16 v139, v135, v120, v139
    v_dot2_f32_bf16 v140, v136, v120, v140
    v_dot2_f32_bf16 v141, v137, v120, v141
    v_lshlrev_b32 v24, 16, v101
    v_lshlrev_b32 v25, 16, v105
    v_lshlrev_b32 v26, 16, v109
    v_lshlrev_b32 v27, 16, v113
    v_pk_mul_f32 v[138:139], v[138:139], v[24:25]
    v_pk_mul_f32 v[140:141], v[140:141], v[26:27]
    v_cvt_pk_bf16_f32 v142, v138, v139
    v_cvt_pk_bf16_f32 v143, v140, v141
    ds_write_b64 v22, v[142:143] offset:256
    v_perm_b32 v132, v73, v77, s89
    v_perm_b32 v133, v77, v81, s89
    v_perm_b32 v134, v81, v85, s89
    v_perm_b32 v135, v85, v89, s89
    v_perm_b32 v136, v89, v93, s89
    v_perm_b32 v137, v93, v97, s89
    v_dot2_f32_bf16 v144, v132, v123, 0
    v_dot2_f32_bf16 v145, v133, v123, 0
    v_dot2_f32_bf16 v146, v134, v123, 0
    v_dot2_f32_bf16 v147, v135, v123, 0
    v_dot2_f32_bf16 v144, v134, v122, v144
    v_dot2_f32_bf16 v145, v135, v122, v145
    v_dot2_f32_bf16 v146, v136, v122, v146
    v_dot2_f32_bf16 v147, v137, v122, v147
    v_and_b32 v24, 0xffff0000, v101
    v_and_b32 v25, 0xffff0000, v105
    v_and_b32 v26, 0xffff0000, v109
    v_and_b32 v27, 0xffff0000, v113
    v_pk_mul_f32 v[144:145], v[144:145], v[24:25]
    v_pk_mul_f32 v[146:147], v[146:147], v[26:27]
    v_cvt_pk_bf16_f32 v148, v144, v145
    v_cvt_pk_bf16_f32 v149, v146, v147
    ds_write_b64 v22, v[148:149] offset:384
    v_perm_b32 v132, v74, v78, s88
    v_perm_b32 v133, v78, v82, s88
    v_perm_b32 v134, v82, v86, s88
    v_perm_b32 v135, v86, v90, s88
    v_perm_b32 v136, v90, v94, s88
    v_perm_b32 v137, v94, v98, s88
    v_dot2_f32_bf16 v138, v132, v125, 0
    v_dot2_f32_bf16 v139, v133, v125, 0
    v_dot2_f32_bf16 v140, v134, v125, 0
    v_dot2_f32_bf16 v141, v135, v125, 0
    v_dot2_f32_bf16 v138, v134, v124, v138
    v_dot2_f32_bf16 v139, v135, v124, v139
    v_dot2_f32_bf16 v140, v136, v124, v140
    v_dot2_f32_bf16 v141, v137, v124, v141
    v_lshlrev_b32 v24, 16, v102
    v_lshlrev_b32 v25, 16, v106
    v_lshlrev_b32 v26, 16, v110
    v_lshlrev_b32 v27, 16, v114
    v_pk_mul_f32 v[138:139], v[138:139], v[24:25]
    v_pk_mul_f32 v[140:141], v[140:141], v[26:27]
    v_cvt_pk_bf16_f32 v142, v138, v139
    v_cvt_pk_bf16_f32 v143, v140, v141
    ds_write_b64 v22, v[142:143] offset:512
    v_perm_b32 v132, v74, v78, s89
    v_perm_b32 v133, v78, v82, s89
    v_perm_b32 v134, v82, v86, s89
    v_perm_b32 v135, v86, v90, s89
    v_perm_b32 v136, v90, v94, s89
    v_perm_b32 v137, v94, v98, s89
    v_dot2_f32_bf16 v144, v132, v127, 0
    v_dot2_f32_bf16 v145, v133, v127, 0
    v_dot2_f32_bf16 v146, v134, v127, 0
    v_dot2_f32_bf16 v147, v135, v127, 0
    v_dot2_f32_bf16 v144, v134, v126, v144
    v_dot2_f32_bf16 v145, v135, v126, v145
    v_dot2_f32_bf16 v146, v136, v126, v146
    v_dot2_f32_bf16 v147, v137, v126, v147
    v_and_b32 v24, 0xffff0000, v102
    v_and_b32 v25, 0xffff0000, v106
    v_and_b32 v26, 0xffff0000, v110
    v_and_b32 v27, 0xffff0000, v114
    v_pk_mul_f32 v[144:145], v[144:145], v[24:25]
    v_pk_mul_f32 v[146:147], v[146:147], v[26:27]
    v_cvt_pk_bf16_f32 v148, v144, v145
    v_cvt_pk_bf16_f32 v149, v146, v147
    ds_write_b64 v22, v[148:149] offset:640
    v_perm_b32 v132, v75, v79, s88
    v_perm_b32 v133, v79, v83, s88
    v_perm_b32 v134, v83, v87, s88
    v_perm_b32 v135, v87, v91, s88
    v_perm_b32 v136, v91, v95, s88
    v_perm_b32 v137, v95, v99, s88
    v_dot2_f32_bf16 v138, v132, v129, 0
    v_dot2_f32_bf16 v139, v133, v129, 0
    v_dot2_f32_bf16 v140, v134, v129, 0
    v_dot2_f32_bf16 v141, v135, v129, 0
    v_dot2_f32_bf16 v138, v134, v128, v138
    v_dot2_f32_bf16 v139, v135, v128, v139
    v_dot2_f32_bf16 v140, v136, v128, v140
    v_dot2_f32_bf16 v141, v137, v128, v141
    v_lshlrev_b32 v24, 16, v103
    v_lshlrev_b32 v25, 16, v107
    v_lshlrev_b32 v26, 16, v111
    v_lshlrev_b32 v27, 16, v115
    v_pk_mul_f32 v[138:139], v[138:139], v[24:25]
    v_pk_mul_f32 v[140:141], v[140:141], v[26:27]
    v_cvt_pk_bf16_f32 v142, v138, v139
    v_cvt_pk_bf16_f32 v143, v140, v141
    ds_write_b64 v22, v[142:143] offset:768
    v_perm_b32 v132, v75, v79, s89
    v_perm_b32 v133, v79, v83, s89
    v_perm_b32 v134, v83, v87, s89
    v_perm_b32 v135, v87, v91, s89
    v_perm_b32 v136, v91, v95, s89
    v_perm_b32 v137, v95, v99, s89
    v_dot2_f32_bf16 v144, v132, v131, 0
    v_dot2_f32_bf16 v145, v133, v131, 0
    v_dot2_f32_bf16 v146, v134, v131, 0
    v_dot2_f32_bf16 v147, v135, v131, 0
    v_dot2_f32_bf16 v144, v134, v130, v144
    v_dot2_f32_bf16 v145, v135, v130, v145
    v_dot2_f32_bf16 v146, v136, v130, v146
    v_dot2_f32_bf16 v147, v137, v130, v147
    v_and_b32 v24, 0xffff0000, v103
    v_and_b32 v25, 0xffff0000, v107
    v_and_b32 v26, 0xffff0000, v111
    v_and_b32 v27, 0xffff0000, v115
    v_pk_mul_f32 v[144:145], v[144:145], v[24:25]
    v_pk_mul_f32 v[146:147], v[146:147], v[26:27]
    v_cvt_pk_bf16_f32 v148, v144, v145
    v_cvt_pk_bf16_f32 v149, v146, v147
    ds_write_b64 v22, v[148:149] offset:896
    s_mov_b64 exec, -1
    s_mul_i32 s86, s49, 20
    v_lshrrev_b32 v22, 3, v0
    v_add_u32 v22, s86, v22
    v_and_b32 v23, 7, v0
    v_add_u32 v24, 0, v22
    v_bfe_u32 v25, v24, 3, 3
    v_xor_b32 v25, v25, v23
    v_lshlrev_b32 v25, 4, v25
    v_lshl_add_u32 v25, v24, 7, v25
    v_add_u32 v26, 153600, v25
    v_add_u32 v24, 8, v22
    v_bfe_u32 v25, v24, 3, 3
    v_xor_b32 v25, v25, v23
    v_lshlrev_b32 v25, 4, v25
    v_lshl_add_u32 v25, v24, 7, v25
    v_add_u32 v27, 153600, v25
    v_add_u32 v24, 16, v22
    v_bfe_u32 v25, v24, 3, 3
    v_xor_b32 v25, v25, v23
    v_lshlrev_b32 v25, 4, v25
    v_lshl_add_u32 v25, v24, 7, v25
    v_add_u32 v28, 153600, v25
    s_mul_i32 s86, s53, 80
    v_add_u32 v22, s86, v22
    v_lshlrev_b32 v22, 12, v22
    v_lshl_add_u32 v22, v23, 4, v22
    s_lshl_b32 s86, s52, 7
    s_add_u32 s86, s86, 3145728
    s_add_u32 s87, s86, 0x8000
    s_add_u32 s88, s86, 0x10000
    s_waitcnt lgkmcnt(0)
    s_barrier
    ds_read_b128 v[72:75], v26
    ds_read_b128 v[76:79], v27
    s_mov_b32 exec_hi, 0
    ds_read_b128 v[80:83], v28
    s_mov_b32 exec_hi, -1
    s_waitcnt lgkmcnt(2)
    buffer_store_dwordx4 v[72:75], v22, s[44:47], s86 offen sc1
    s_waitcnt lgkmcnt(1)
    buffer_store_dwordx4 v[76:79], v22, s[44:47], s87 offen sc1
    s_waitcnt lgkmcnt(0)
    s_mov_b32 exec_hi, 0
    buffer_store_dwordx4 v[80:83], v22, s[44:47], s88 offen sc1
    s_mov_b32 exec_hi, -1
    s_lshl_b32 s90, s53, 2
    s_add_u32 s90, s90, s49
    s_lshl_b32 s90, s90, 5
    s_add_u32 s90, s90, s52
    s_lshl_b32 s90, s90, 7
    s_add_u32 s90, s90, 4096
    s_bitcmp1_b32 s98, 0
    s_cbranch_scc1 R_G1
    s_bitcmp1_b32 s98, 2
    s_cbranch_scc1 R_LN
    s_waitcnt vmcnt(3)
    s_bitcmp1_b32 s98, 3
    s_cbranch_scc0 G2_NP
    v_lshrrev_b32 v70, 5, v0
    v_bfe_u32 v14, v0, 4, 1
    v_lshl_add_u32 v70, v70, 2, v14
    v_bfe_u32 v14, v0, 2, 2
    v_lshl_add_u32 v70, v70, 2, v14
    v_mul_u32_u24 v70, 320, v70
    v_and_b32 v14, 3, v0
    v_lshl_add_u32 v70, v14, 3, v70
    v_add_u32 v70, s82, v70
    s_mul_i32 s86, s49, 108
    s_add_u32 s86, s86, s32
    s_mul_i32 s86, s86, 5120
    s_add_u32 s86, s86, 38797312
    s_lshl_b32 s91, s32, 2
    s_add_u32 s91, s91, s49
    s_lshl_b32 s91, s91, 7
    s_add_u32 s91, s91, 593920
    ds_read_b64_tr_b16 v[136:137], v70 offset:0
    ds_read_b64_tr_b16 v[138:139], v70 offset:2560
    ds_read_b64_tr_b16 v[140:141], v70 offset:32
    ds_read_b64_tr_b16 v[142:143], v70 offset:2592
    ds_read_b64_tr_b16 v[144:145], v70 offset:64
    ds_read_b64_tr_b16 v[146:147], v70 offset:2624
    ds_read_b64_tr_b16 v[148:149], v70 offset:96
    ds_read_b64_tr_b16 v[150:151], v70 offset:2656
    ds_read_b64_tr_b16 v[152:153], v70 offset:128
    ds_read_b64_tr_b16 v[154:155], v70 offset:2688
    ds_read_b64_tr_b16 v[156:157], v70 offset:160
    ds_read_b64_tr_b16 v[158:159], v70 offset:2720
    ds_read_b64_tr_b16 v[160:161], v70 offset:192
    ds_read_b64_tr_b16 v[162:163], v70 offset:2752
    ds_read_b64_tr_b16 v[164:165], v70 offset:224
    ds_read_b64_tr_b16 v[166:167], v70 offset:2784
    ds_read_b64_tr_b16 v[168:169], v70 offset:256
    ds_read_b64_tr_b16 v[170:171], v70 offset:2816
    ds_read_b64_tr_b16 v[172:173], v70 offset:288
    ds_read_b64_tr_b16 v[174:175], v70 offset:2848
    s_waitcnt lgkmcnt(15)
    buffer_store_dwordx4 v[136:139], v1, s[44:47], s86 offen offset:0 sc1
    buffer_store_dwordx4 v[140:143], v1, s[44:47], s86 offen offset:1024 sc1
    s_waitcnt lgkmcnt(14)
    buffer_store_dwordx4 v[144:147], v1, s[44:47], s86 offen offset:2048 sc1
    s_waitcnt lgkmcnt(12)
    buffer_store_dwordx4 v[148:151], v1, s[44:47], s86 offen offset:3072 sc1
    s_waitcnt lgkmcnt(10)
    s_add_u32 s86, s86, 4096
    buffer_store_dwordx4 v[152:155], v1, s[44:47], s86 offen offset:0 sc1
    s_add_u32 s86, s86, 272384
    s_waitcnt lgkmcnt(8)
    buffer_store_dwordx4 v[156:159], v1, s[44:47], s86 offen offset:0 sc1
    s_waitcnt lgkmcnt(6)
    buffer_store_dwordx4 v[160:163], v1, s[44:47], s86 offen offset:1024 sc1
    s_waitcnt lgkmcnt(4)
    buffer_store_dwordx4 v[164:167], v1, s[44:47], s86 offen offset:2048 sc1
    s_waitcnt lgkmcnt(2)
    buffer_store_dwordx4 v[168:171], v1, s[44:47], s86 offen offset:3072 sc1
    s_waitcnt lgkmcnt(0)
    s_add_u32 s86, s86, 4096
    buffer_store_dwordx4 v[172:175], v1, s[44:47], s86 offen offset:0 sc1
    s_waitcnt vmcnt(10)
    s_mov_b64 exec, 1
    buffer_store_dword v15, off, s[44:47], s90 sc1
    s_mov_b64 exec, -1
    s_waitcnt vmcnt(1)
    s_mov_b64 exec, 1
    buffer_store_dword v15, off, s[44:47], s91 sc1
    s_mov_b64 exec, -1
    s_branch G2_P
G2_NP:
    s_waitcnt vmcnt(0)
    s_mov_b64 exec, 1
    buffer_store_dword v15, off, s[44:47], s90 sc1
    s_mov_b64 exec, -1
G2_P:
    s_call_b64 s[94:95], WD_ALL
    s_mov_b32 s74, 0
G2_LOOP:
    s_call_b64 s[92:93], G_SUB
    s_add_u32 s74, s74, 1
    s_cmp_lt_u32 s74, 8
    s_cbranch_scc1 G2_LOOP
    s_branch DONE
R_LN:
    s_lshl_b32 s86, s50, 2
    s_add_u32 s54, s86, s51
    s_sub_u32 s54, s54, 28
    v_lshrrev_b32 v16, 4, v0
    s_lshl_b32 s86, s49, 2
    v_add_u32 v21, s86, v16
    v_and_b32 v17, 15, v0
    v_mul_u32_u24 v18, 1280, v21
    v_lshl_add_u32 v8, v17, 4, v18
    v_mul_u32_u24 v18, 160, v21
    v_add_u32 v19, 0, v17
    v_mul_u32_u24 v20, 205, v19
    v_lshrrev_b32 v20, 11, v20
    v_mul_u32_u24 v20, 2400, v20
    v_lshl_add_u32 v20, v19, 4, v20
    v_add_u32 v2, v20, v18
    v_add_u32 v19, 16, v17
    v_mul_u32_u24 v20, 205, v19
    v_lshrrev_b32 v20, 11, v20
    v_mul_u32_u24 v20, 2400, v20
    v_lshl_add_u32 v20, v19, 4, v20
    v_add_u32 v3, v20, v18
    v_add_u32 v19, 32, v17
    v_mul_u32_u24 v20, 205, v19
    v_lshrrev_b32 v20, 11, v20
    v_mul_u32_u24 v20, 2400, v20
    v_lshl_add_u32 v20, v19, 4, v20
    v_add_u32 v4, v20, v18
    v_add_u32 v19, 48, v17
    v_mul_u32_u24 v20, 205, v19
    v_lshrrev_b32 v20, 11, v20
    v_mul_u32_u24 v20, 2400, v20
    v_lshl_add_u32 v20, v19, 4, v20
    v_add_u32 v5, v20, v18
    v_add_u32 v19, 64, v17
    v_mul_u32_u24 v20, 205, v19
    v_lshrrev_b32 v20, 11, v20
    v_mul_u32_u24 v20, 2400, v20
    v_lshl_add_u32 v20, v19, 4, v20
    v_add_u32 v6, v20, v18
    v_lshrrev_b32 v18, 2, v17
    v_lshlrev_b32 v18, 10, v18
    v_and_b32 v19, 3, v0
    v_lshl_add_u32 v18, v19, 6, v18
    v_lshl_add_u32 v18, v16, 4, v18
    s_and_b32 s86, s49, 1
    s_lshl_b32 s86, s86, 8
    s_lshr_b32 s87, s49, 1
    s_lshl_b32 s87, s87, 3
    s_add_u32 s86, s86, s87
    v_add_u32 v10, s86, v18
    v_bfe_u32 v18, v0, 2, 2
    v_lshrrev_b32 v20, 5, v0
    v_lshl_add_u32 v18, v18, 1, v20
    v_and_b32 v20, 1, v16
    v_lshl_add_u32 v19, v20, 2, v19
    v_lshlrev_b32 v19, 4, v19
    v_lshl_add_u32 v68, v18, 7, v19
    v_min_u32 v18, 39, v0
    s_mul_i32 s86, s49, 40
    v_add_u32 v18, s86, v18
    v_lshlrev_b32 v69, 7, v18
    v_lshrrev_b32 v18, 3, v21
    v_mul_u32_u24 v18, 10240, v18
    v_lshrrev_b32 v19, 3, v17
    v_lshl_add_u32 v18, v19, 10, v18
    v_and_b32 v19, 7, v21
    v_lshl_add_u32 v18, v19, 7, v18
    v_lshrrev_b32 v19, 1, v21
    v_xor_b32 v19, v19, v17
    v_and_b32 v19, 7, v19
    v_lshl_add_u32 v70, v19, 4, v18
    s_mov_b32 s7, 0x3acccccd
    s_mov_b32 s12, 0x00003f80
    s_mov_b32 s13, 0x3f800000
    s_mov_b32 s15, 0xffff0000
    s_lshr_b32 s14, s54, 3
    s_mul_i32 s14, s14, 20480
    s_add_u32 s14, s14, 135168
    s_waitcnt vmcnt(0)
    s_mov_b64 exec, 1
    buffer_store_dword v15, off, s[44:47], s90 sc1
    s_mov_b64 exec, -1
    s_mul_i32 s86, s54, 20480
    buffer_load_dwordx4 v[152:155], v8, s[24:27], s86 offen offset:0
    buffer_load_dwordx4 v[156:159], v8, s[24:27], s86 offen offset:256
    buffer_load_dwordx4 v[160:163], v8, s[24:27], s86 offen offset:512
    buffer_load_dwordx4 v[164:167], v8, s[24:27], s86 offen offset:768
    buffer_load_dwordx4 v[168:171], v8, s[24:27], s86 offen offset:1024
    s_add_u32 s86, s86, 655360
    buffer_load_dwordx4 v[172:175], v8, s[24:27], s86 offen offset:0
    buffer_load_dwordx4 v[176:179], v8, s[24:27], s86 offen offset:256
    buffer_load_dwordx4 v[180:183], v8, s[24:27], s86 offen offset:512
    buffer_load_dwordx4 v[184:187], v8, s[24:27], s86 offen offset:768
    buffer_load_dwordx4 v[188:191], v8, s[24:27], s86 offen offset:1024
    s_add_u32 s86, s86, 655360
    buffer_load_dwordx4 v[192:195], v8, s[24:27], s86 offen offset:0
    buffer_load_dwordx4 v[196:199], v8, s[24:27], s86 offen offset:256
    buffer_load_dwordx4 v[200:203], v8, s[24:27], s86 offen offset:512
    buffer_load_dwordx4 v[204:207], v8, s[24:27], s86 offen offset:768
    buffer_load_dwordx4 v[208:211], v8, s[24:27], s86 offen offset:1024
    s_add_u32 s86, s86, 655360
    buffer_load_dwordx4 v[212:215], v8, s[24:27], s86 offen offset:0
    buffer_load_dwordx4 v[216:219], v8, s[24:27], s86 offen offset:256
    buffer_load_dwordx4 v[220:223], v8, s[24:27], s86 offen offset:512
    buffer_load_dwordx4 v[224:227], v8, s[24:27], s86 offen offset:768
    buffer_load_dwordx4 v[228:231], v8, s[24:27], s86 offen offset:1024
    v_mov_b32 v8, v70
    s_mul_i32 s86, s49, 14
    v_add_u32 v70, s86, v0
    s_add_u32 s87, s86, 13
    s_min_u32 s87, s87, 53
    v_min_u32 v70, s87, v70
    v_lshlrev_b32 v70, 9, v70
    s_lshr_b32 s89, s53, 1
    s_lshl_b32 s89, s89, 7
    s_add_u32 s89, s89, 593920
    s_mul_i32 s84, s53, 54
    s_add_u32 s84, s84, s86
    s_mul_i32 s84, s84, 5120
    s_add_u32 s84, s84, 38797312
    s_mov_b32 s69, 65536
POLL_1:
    buffer_load_dword v14, v70, s[44:47], s89 offen sc1
    s_waitcnt vmcnt(0)
    v_cmp_ne_u32 vcc, s48, v14
    s_cbranch_vccz PDONE_2
    s_sub_u32 s69, s69, 1
    s_cbranch_scc0 POLL_1
PDONE_2:
    v_lshlrev_b32 v72, 16, v212
    v_and_b32 v73, s15, v212
    buffer_load_dwordx4 v[232:235], v1, s[44:47], s84 offen offset:0 sc1
    v_lshlrev_b32 v74, 16, v213
    v_and_b32 v75, s15, v213
    buffer_load_dwordx4 v[236:239], v1, s[44:47], s84 offen offset:1024 sc1
    v_lshlrev_b32 v76, 16, v214
    v_and_b32 v77, s15, v214
    buffer_load_dwordx4 v[240:243], v1, s[44:47], s84 offen offset:2048 sc1
    v_lshlrev_b32 v78, 16, v215
    v_and_b32 v79, s15, v215
    buffer_load_dwordx4 v[244:247], v1, s[44:47], s84 offen offset:3072 sc1
    s_add_u32 s84, s84, 4096
    v_lshlrev_b32 v80, 16, v216
    v_and_b32 v81, s15, v216
    buffer_load_dwordx4 v[248:251], v1, s[44:47], s84 offen offset:0 sc1
    v_lshlrev_b32 v82, 16, v217
    v_and_b32 v83, s15, v217
    buffer_load_dwordx4 v[252:255], v1, s[44:47], s84 offen offset:1024 sc1
    v_lshlrev_b32 v84, 16, v218
    v_and_b32 v85, s15, v218
    buffer_load_dwordx4 a[0:3], v1, s[44:47], s84 offen offset:2048 sc1
    v_lshlrev_b32 v86, 16, v219
    v_and_b32 v87, s15, v219
    buffer_load_dwordx4 a[32:35], v1, s[44:47], s84 offen offset:3072 sc1
    s_add_u32 s84, s84, 4096
    v_lshlrev_b32 v88, 16, v220
    v_and_b32 v89, s15, v220
    buffer_load_dwordx4 a[64:67], v1, s[44:47], s84 offen offset:0 sc1
    v_lshlrev_b32 v90, 16, v221
    v_and_b32 v91, s15, v221
    buffer_load_dwordx4 a[96:99], v1, s[44:47], s84 offen offset:1024 sc1
    v_lshlrev_b32 v92, 16, v222
    v_and_b32 v93, s15, v222
    buffer_load_dwordx4 a[156:159], v1, s[44:47], s84 offen offset:2048 sc1
    v_lshlrev_b32 v94, 16, v223
    v_and_b32 v95, s15, v223
    buffer_load_dwordx4 a[188:191], v1, s[44:47], s84 offen offset:3072 sc1
    s_add_u32 s84, s84, 4096
    v_lshlrev_b32 v96, 16, v224
    v_and_b32 v97, s15, v224
    buffer_load_dwordx4 a[220:223], v1, s[44:47], s84 offen offset:0 sc1
    v_lshlrev_b32 v98, 16, v225
    v_and_b32 v99, s15, v225
    buffer_load_dwordx4 a[252:255], v1, s[44:47], s84 offen offset:1024 sc1
    v_lshlrev_b32 v100, 16, v226
    v_and_b32 v101, s15, v226
    v_lshlrev_b32 v102, 16, v227
    v_and_b32 v103, s15, v227
    v_lshlrev_b32 v104, 16, v228
    v_and_b32 v105, s15, v228
    v_lshlrev_b32 v106, 16, v229
    v_and_b32 v107, s15, v229
    v_lshlrev_b32 v108, 16, v230
    v_and_b32 v109, s15, v230
    v_lshlrev_b32 v110, 16, v231
    v_and_b32 v111, s15, v231
    s_call_b64 s[94:95], LN_PRE
    v_mov_b32 v150, v58
    v_mov_b32 v151, v56
    v_lshlrev_b32 v72, 16, v192
    v_and_b32 v73, s15, v192
    buffer_load_dwordx4 a[4:7], v1, s[44:47], s84 offen offset:2048 sc1
    v_lshlrev_b32 v74, 16, v193
    v_and_b32 v75, s15, v193
    buffer_load_dwordx4 a[36:39], v1, s[44:47], s84 offen offset:3072 sc1
    s_add_u32 s84, s84, 4096
    v_lshlrev_b32 v76, 16, v194
    v_and_b32 v77, s15, v194
    buffer_load_dwordx4 a[68:71], v1, s[44:47], s84 offen offset:0 sc1
    v_lshlrev_b32 v78, 16, v195
    v_and_b32 v79, s15, v195
    buffer_load_dwordx4 a[100:103], v1, s[44:47], s84 offen offset:1024 sc1
    v_lshlrev_b32 v80, 16, v196
    v_and_b32 v81, s15, v196
    buffer_load_dwordx4 a[152:155], v1, s[44:47], s84 offen offset:2048 sc1
    v_lshlrev_b32 v82, 16, v197
    v_and_b32 v83, s15, v197
    buffer_load_dwordx4 a[184:187], v1, s[44:47], s84 offen offset:3072 sc1
    s_add_u32 s84, s84, 4096
    v_lshlrev_b32 v84, 16, v198
    v_and_b32 v85, s15, v198
    buffer_load_dwordx4 a[216:219], v1, s[44:47], s84 offen offset:0 sc1
    v_lshlrev_b32 v86, 16, v199
    v_and_b32 v87, s15, v199
    buffer_load_dwordx4 a[248:251], v1, s[44:47], s84 offen offset:1024 sc1
    v_lshlrev_b32 v88, 16, v200
    v_and_b32 v89, s15, v200
    buffer_load_dwordx4 a[8:11], v1, s[44:47], s84 offen offset:2048 sc1
    v_lshlrev_b32 v90, 16, v201
    v_and_b32 v91, s15, v201
    buffer_load_dwordx4 a[40:43], v1, s[44:47], s84 offen offset:3072 sc1
    s_add_u32 s84, s84, 4096
    v_lshlrev_b32 v92, 16, v202
    v_and_b32 v93, s15, v202
    buffer_load_dwordx4 a[72:75], v1, s[44:47], s84 offen offset:0 sc1
    v_lshlrev_b32 v94, 16, v203
    v_and_b32 v95, s15, v203
    buffer_load_dwordx4 a[104:107], v1, s[44:47], s84 offen offset:1024 sc1
    v_lshlrev_b32 v96, 16, v204
    v_and_b32 v97, s15, v204
    buffer_load_dwordx4 a[148:151], v1, s[44:47], s84 offen offset:2048 sc1
    v_lshlrev_b32 v98, 16, v205
    v_and_b32 v99, s15, v205
    buffer_load_dwordx4 a[180:183], v1, s[44:47], s84 offen offset:3072 sc1
    s_add_u32 s84, s84, 4096
    v_lshlrev_b32 v100, 16, v206
    v_and_b32 v101, s15, v206
    v_lshlrev_b32 v102, 16, v207
    v_and_b32 v103, s15, v207
    v_lshlrev_b32 v104, 16, v208
    v_and_b32 v105, s15, v208
    v_lshlrev_b32 v106, 16, v209
    v_and_b32 v107, s15, v209
    v_lshlrev_b32 v108, 16, v210
    v_and_b32 v109, s15, v210
    v_lshlrev_b32 v110, 16, v211
    v_and_b32 v111, s15, v211
    s_call_b64 s[94:95], LN_PRE
    v_mov_b32 v148, v58
    v_mov_b32 v149, v56
    v_lshlrev_b32 v72, 16, v172
    v_and_b32 v73, s15, v172
    buffer_load_dwordx4 a[212:215], v1, s[44:47], s84 offen offset:0 sc1
    v_lshlrev_b32 v74, 16, v173
    v_and_b32 v75, s15, v173
    buffer_load_dwordx4 a[244:247], v1, s[44:47], s84 offen offset:1024 sc1
    v_lshlrev_b32 v76, 16, v174
    v_and_b32 v77, s15, v174
    buffer_load_dwordx4 a[12:15], v1, s[44:47], s84 offen offset:2048 sc1
    v_lshlrev_b32 v78, 16, v175
    v_and_b32 v79, s15, v175
    buffer_load_dwordx4 a[44:47], v1, s[44:47], s84 offen offset:3072 sc1
    s_add_u32 s84, s84, 4096
    v_lshlrev_b32 v80, 16, v176
    v_and_b32 v81, s15, v176
    buffer_load_dwordx4 a[76:79], v1, s[44:47], s84 offen offset:0 sc1
    v_lshlrev_b32 v82, 16, v177
    v_and_b32 v83, s15, v177
    buffer_load_dwordx4 a[108:111], v1, s[44:47], s84 offen offset:1024 sc1
    v_lshlrev_b32 v84, 16, v178
    v_and_b32 v85, s15, v178
    buffer_load_dwordx4 a[144:147], v1, s[44:47], s84 offen offset:2048 sc1
    v_lshlrev_b32 v86, 16, v179
    v_and_b32 v87, s15, v179
    buffer_load_dwordx4 a[176:179], v1, s[44:47], s84 offen offset:3072 sc1
    s_add_u32 s84, s84, 4096
    v_lshlrev_b32 v88, 16, v180
    v_and_b32 v89, s15, v180
    buffer_load_dwordx4 a[208:211], v1, s[44:47], s84 offen offset:0 sc1
    v_lshlrev_b32 v90, 16, v181
    v_and_b32 v91, s15, v181
    buffer_load_dwordx4 a[240:243], v1, s[44:47], s84 offen offset:1024 sc1
    v_lshlrev_b32 v92, 16, v182
    v_and_b32 v93, s15, v182
    buffer_load_dwordx4 a[16:19], v1, s[44:47], s84 offen offset:2048 sc1
    v_lshlrev_b32 v94, 16, v183
    v_and_b32 v95, s15, v183
    buffer_load_dwordx4 a[48:51], v1, s[44:47], s84 offen offset:3072 sc1
    s_add_u32 s84, s84, 4096
    v_lshlrev_b32 v96, 16, v184
    v_and_b32 v97, s15, v184
    buffer_load_dwordx4 a[80:83], v1, s[44:47], s84 offen offset:0 sc1
    v_lshlrev_b32 v98, 16, v185
    v_and_b32 v99, s15, v185
    buffer_load_dwordx4 a[112:115], v1, s[44:47], s84 offen offset:1024 sc1
    v_lshlrev_b32 v100, 16, v186
    v_and_b32 v101, s15, v186
    v_lshlrev_b32 v102, 16, v187
    v_and_b32 v103, s15, v187
    v_lshlrev_b32 v104, 16, v188
    v_and_b32 v105, s15, v188
    v_lshlrev_b32 v106, 16, v189
    v_and_b32 v107, s15, v189
    v_lshlrev_b32 v108, 16, v190
    v_and_b32 v109, s15, v190
    v_lshlrev_b32 v110, 16, v191
    v_and_b32 v111, s15, v191
    s_call_b64 s[94:95], LN_PRE
    v_mov_b32 v146, v58
    v_mov_b32 v147, v56
    v_lshlrev_b32 v72, 16, v152
    v_and_b32 v73, s15, v152
    buffer_load_dwordx4 a[140:143], v1, s[44:47], s84 offen offset:2048 sc1
    v_lshlrev_b32 v74, 16, v153
    v_and_b32 v75, s15, v153
    buffer_load_dwordx4 a[172:175], v1, s[44:47], s84 offen offset:3072 sc1
    s_add_u32 s84, s84, 4096
    v_lshlrev_b32 v76, 16, v154
    v_and_b32 v77, s15, v154
    buffer_load_dwordx4 a[204:207], v1, s[44:47], s84 offen offset:0 sc1
    v_lshlrev_b32 v78, 16, v155
    v_and_b32 v79, s15, v155
    buffer_load_dwordx4 a[236:239], v1, s[44:47], s84 offen offset:1024 sc1
    v_lshlrev_b32 v80, 16, v156
    v_and_b32 v81, s15, v156
    buffer_load_dwordx4 a[24:27], v1, s[44:47], s84 offen offset:2048 sc1
    v_lshlrev_b32 v82, 16, v157
    v_and_b32 v83, s15, v157
    buffer_load_dwordx4 a[56:59], v1, s[44:47], s84 offen offset:3072 sc1
    s_add_u32 s84, s84, 4096
    v_lshlrev_b32 v84, 16, v158
    v_and_b32 v85, s15, v158
    buffer_load_dwordx4 a[88:91], v1, s[44:47], s84 offen offset:0 sc1
    v_lshlrev_b32 v86, 16, v159
    v_and_b32 v87, s15, v159
    v_lshlrev_b32 v88, 16, v160
    v_and_b32 v89, s15, v160
    v_lshlrev_b32 v90, 16, v161
    v_and_b32 v91, s15, v161
    v_lshlrev_b32 v92, 16, v162
    v_and_b32 v93, s15, v162
    v_lshlrev_b32 v94, 16, v163
    v_and_b32 v95, s15, v163
    v_lshlrev_b32 v96, 16, v164
    v_and_b32 v97, s15, v164
    v_lshlrev_b32 v98, 16, v165
    v_and_b32 v99, s15, v165
    v_lshlrev_b32 v100, 16, v166
    v_and_b32 v101, s15, v166
    v_lshlrev_b32 v102, 16, v167
    v_and_b32 v103, s15, v167
    v_lshlrev_b32 v104, 16, v168
    v_and_b32 v105, s15, v168
    v_lshlrev_b32 v106, 16, v169
    v_and_b32 v107, s15, v169
    v_lshlrev_b32 v108, 16, v170
    v_and_b32 v109, s15, v170
    v_lshlrev_b32 v110, 16, v171
    v_and_b32 v111, s15, v171
    s_call_b64 s[94:95], LN_PRE
    v_mov_b32 v142, v58
    v_mov_b32 v143, v56
    s_mov_b32 s68, 0
    s_lshl_b32 s76, s2, 2
    s_add_u32 s76, s76, s49
    s_lshl_b32 s76, s76, 7
    s_add_u32 s76, s76, 1544192
    s_mul_i32 s88, s54, 20480
    s_mul_i32 m0, s49, 5120
    s_add_u32 s88, s88, m0
    s_add_u32 s88, s88, 6291456
    s_call_b64 s[92:93], Y_FIRST
    s_call_b64 s[92:93], LN1B
    v_pk_mov_b32 v[152:153], v[16:17], v[16:17] op_sel:[0,1]
    v_pk_mov_b32 v[154:155], v[18:19], v[18:19] op_sel:[0,1]
    v_pk_mov_b32 v[156:157], v[20:21], v[20:21] op_sel:[0,1]
    v_pk_mov_b32 v[158:159], v[22:23], v[22:23] op_sel:[0,1]
    v_pk_mov_b32 v[160:161], v[24:25], v[24:25] op_sel:[0,1]
    v_pk_mov_b32 v[162:163], v[26:27], v[26:27] op_sel:[0,1]
    v_pk_mov_b32 v[164:165], v[28:29], v[28:29] op_sel:[0,1]
    v_pk_mov_b32 v[166:167], v[30:31], v[30:31] op_sel:[0,1]
    v_pk_mov_b32 v[168:169], v[32:33], v[32:33] op_sel:[0,1]
    v_pk_mov_b32 v[170:171], v[34:35], v[34:35] op_sel:[0,1]
    v_lshlrev_b32 v72, 16, v172
    v_and_b32 v73, s15, v172
    v_lshlrev_b32 v74, 16, v173
    v_and_b32 v75, s15, v173
    v_lshlrev_b32 v76, 16, v174
    v_and_b32 v77, s15, v174
    v_lshlrev_b32 v78, 16, v175
    v_and_b32 v79, s15, v175
    v_lshlrev_b32 v80, 16, v176
    v_and_b32 v81, s15, v176
    v_lshlrev_b32 v82, 16, v177
    v_and_b32 v83, s15, v177
    v_lshlrev_b32 v84, 16, v178
    v_and_b32 v85, s15, v178
    v_lshlrev_b32 v86, 16, v179
    v_and_b32 v87, s15, v179
    v_lshlrev_b32 v88, 16, v180
    v_and_b32 v89, s15, v180
    v_lshlrev_b32 v90, 16, v181
    v_and_b32 v91, s15, v181
    v_lshlrev_b32 v92, 16, v182
    v_and_b32 v93, s15, v182
    v_lshlrev_b32 v94, 16, v183
    v_and_b32 v95, s15, v183
    v_lshlrev_b32 v96, 16, v184
    v_and_b32 v97, s15, v184
    v_lshlrev_b32 v98, 16, v185
    v_and_b32 v99, s15, v185
    v_lshlrev_b32 v100, 16, v186
    v_and_b32 v101, s15, v186
    v_lshlrev_b32 v102, 16, v187
    v_and_b32 v103, s15, v187
    v_lshlrev_b32 v104, 16, v188
    v_and_b32 v105, s15, v188
    v_lshlrev_b32 v106, 16, v189
    v_and_b32 v107, s15, v189
    v_lshlrev_b32 v108, 16, v190
    v_and_b32 v109, s15, v190
    v_lshlrev_b32 v110, 16, v191
    v_and_b32 v111, s15, v191
    v_mov_b32 v142, v146
    v_mov_b32 v143, v147
    s_mov_b32 s68, 1
    s_cmp_lg_u32 s62, 0
    s_cbranch_scc1 Y_OK0
    s_call_b64 s[92:93], Y_LATE
Y_OK0:
    s_call_b64 s[92:93], LN1B
    v_pk_mov_b32 v[172:173], v[16:17], v[16:17] op_sel:[0,1]
    v_pk_mov_b32 v[174:175], v[18:19], v[18:19] op_sel:[0,1]
    v_pk_mov_b32 v[176:177], v[20:21], v[20:21] op_sel:[0,1]
    v_pk_mov_b32 v[178:179], v[22:23], v[22:23] op_sel:[0,1]
    v_pk_mov_b32 v[180:181], v[24:25], v[24:25] op_sel:[0,1]
    v_pk_mov_b32 v[182:183], v[26:27], v[26:27] op_sel:[0,1]
    v_pk_mov_b32 v[184:185], v[28:29], v[28:29] op_sel:[0,1]
    v_pk_mov_b32 v[186:187], v[30:31], v[30:31] op_sel:[0,1]
    v_pk_mov_b32 v[188:189], v[32:33], v[32:33] op_sel:[0,1]
    v_pk_mov_b32 v[190:191], v[34:35], v[34:35] op_sel:[0,1]
    v_lshlrev_b32 v72, 16, v192
    v_and_b32 v73, s15, v192
    v_lshlrev_b32 v74, 16, v193
    v_and_b32 v75, s15, v193
    v_lshlrev_b32 v76, 16, v194
    v_and_b32 v77, s15, v194
    v_lshlrev_b32 v78, 16, v195
    v_and_b32 v79, s15, v195
    v_lshlrev_b32 v80, 16, v196
    v_and_b32 v81, s15, v196
    v_lshlrev_b32 v82, 16, v197
    v_and_b32 v83, s15, v197
    v_lshlrev_b32 v84, 16, v198
    v_and_b32 v85, s15, v198
    v_lshlrev_b32 v86, 16, v199
    v_and_b32 v87, s15, v199
    v_lshlrev_b32 v88, 16, v200
    v_and_b32 v89, s15, v200
    v_lshlrev_b32 v90, 16, v201
    v_and_b32 v91, s15, v201
    v_lshlrev_b32 v92, 16, v202
    v_and_b32 v93, s15, v202
    v_lshlrev_b32 v94, 16, v203
    v_and_b32 v95, s15, v203
    v_lshlrev_b32 v96, 16, v204
    v_and_b32 v97, s15, v204
    v_lshlrev_b32 v98, 16, v205
    v_and_b32 v99, s15, v205
    v_lshlrev_b32 v100, 16, v206
    v_and_b32 v101, s15, v206
    v_lshlrev_b32 v102, 16, v207
    v_and_b32 v103, s15, v207
    v_lshlrev_b32 v104, 16, v208
    v_and_b32 v105, s15, v208
    v_lshlrev_b32 v106, 16, v209
    v_and_b32 v107, s15, v209
    v_lshlrev_b32 v108, 16, v210
    v_and_b32 v109, s15, v210
    v_lshlrev_b32 v110, 16, v211
    v_and_b32 v111, s15, v211
    v_mov_b32 v142, v148
    v_mov_b32 v143, v149
    s_mov_b32 s68, 2
    s_cmp_lg_u32 s62, 0
    s_cbranch_scc1 Y_OK1
    s_call_b64 s[92:93], Y_LATE
Y_OK1:
    s_call_b64 s[92:93], LN1B
    v_pk_mov_b32 v[192:193], v[16:17], v[16:17] op_sel:[0,1]
    v_pk_mov_b32 v[194:195], v[18:19], v[18:19] op_sel:[0,1]
    v_pk_mov_b32 v[196:197], v[20:21], v[20:21] op_sel:[0,1]
    v_pk_mov_b32 v[198:199], v[22:23], v[22:23] op_sel:[0,1]
    v_pk_mov_b32 v[200:201], v[24:25], v[24:25] op_sel:[0,1]
    v_pk_mov_b32 v[202:203], v[26:27], v[26:27] op_sel:[0,1]
    v_pk_mov_b32 v[204:205], v[28:29], v[28:29] op_sel:[0,1]
    v_pk_mov_b32 v[206:207], v[30:31], v[30:31] op_sel:[0,1]
    v_pk_mov_b32 v[208:209], v[32:33], v[32:33] op_sel:[0,1]
    v_pk_mov_b32 v[210:211], v[34:35], v[34:35] op_sel:[0,1]
    v_lshlrev_b32 v72, 16, v212
    v_and_b32 v73, s15, v212
    v_lshlrev_b32 v74, 16, v213
    v_and_b32 v75, s15, v213
    v_lshlrev_b32 v76, 16, v214
    v_and_b32 v77, s15, v214
    v_lshlrev_b32 v78, 16, v215
    v_and_b32 v79, s15, v215
    v_lshlrev_b32 v80, 16, v216
    v_and_b32 v81, s15, v216
    v_lshlrev_b32 v82, 16, v217
    v_and_b32 v83, s15, v217
    v_lshlrev_b32 v84, 16, v218
    v_and_b32 v85, s15, v218
    v_lshlrev_b32 v86, 16, v219
    v_and_b32 v87, s15, v219
    v_lshlrev_b32 v88, 16, v220
    v_and_b32 v89, s15, v220
    v_lshlrev_b32 v90, 16, v221
    v_and_b32 v91, s15, v221
    v_lshlrev_b32 v92, 16, v222
    v_and_b32 v93, s15, v222
    v_lshlrev_b32 v94, 16, v223
    v_and_b32 v95, s15, v223
    v_lshlrev_b32 v96, 16, v224
    v_and_b32 v97, s15, v224
    v_lshlrev_b32 v98, 16, v225
    v_and_b32 v99, s15, v225
    v_lshlrev_b32 v100, 16, v226
    v_and_b32 v101, s15, v226
    v_lshlrev_b32 v102, 16, v227
    v_and_b32 v103, s15, v227
    v_lshlrev_b32 v104, 16, v228
    v_and_b32 v105, s15, v228
    v_lshlrev_b32 v106, 16, v229
    v_and_b32 v107, s15, v229
    v_lshlrev_b32 v108, 16, v230
    v_and_b32 v109, s15, v230
    v_lshlrev_b32 v110, 16, v231
    v_and_b32 v111, s15, v231
    v_mov_b32 v142, v150
    v_mov_b32 v143, v151
    s_mov_b32 s68, 3
    s_cmp_lg_u32 s62, 0
    s_cbranch_scc1 Y_OK2
    s_call_b64 s[92:93], Y_LATE
Y_OK2:
    s_call_b64 s[92:93], LN1B
    v_pk_mov_b32 v[212:213], v[16:17], v[16:17] op_sel:[0,1]
    v_pk_mov_b32 v[214:215], v[18:19], v[18:19] op_sel:[0,1]
    v_pk_mov_b32 v[216:217], v[20:21], v[20:21] op_sel:[0,1]
    v_pk_mov_b32 v[218:219], v[22:23], v[22:23] op_sel:[0,1]
    v_pk_mov_b32 v[220:221], v[24:25], v[24:25] op_sel:[0,1]
    v_pk_mov_b32 v[222:223], v[26:27], v[26:27] op_sel:[0,1]
    v_pk_mov_b32 v[224:225], v[28:29], v[28:29] op_sel:[0,1]
    v_pk_mov_b32 v[226:227], v[30:31], v[30:31] op_sel:[0,1]
    v_pk_mov_b32 v[228:229], v[32:33], v[32:33] op_sel:[0,1]
    v_pk_mov_b32 v[230:231], v[34:35], v[34:35] op_sel:[0,1]
    buffer_load_dwordx4 a[120:123], v1, s[44:47], s84 offen offset:1024 sc1
    buffer_load_dwordx4 a[132:135], v1, s[44:47], s84 offen offset:2048 sc1
    buffer_load_dwordx4 a[164:167], v1, s[44:47], s84 offen offset:3072 sc1
    s_add_u32 s84, s84, 4096
    buffer_load_dwordx4 a[196:199], v1, s[44:47], s84 offen offset:0 sc1
    buffer_load_dwordx4 a[228:231], v1, s[44:47], s84 offen offset:1024 sc1
    buffer_load_dwordx4 a[20:23], v1, s[44:47], s84 offen offset:2048 sc1
    buffer_load_dwordx4 a[52:55], v1, s[44:47], s84 offen offset:3072 sc1
    s_add_u32 s84, s84, 4096
    buffer_load_dwordx4 a[84:87], v1, s[44:47], s84 offen offset:0 sc1
    buffer_load_dwordx4 a[116:119], v1, s[44:47], s84 offen offset:1024 sc1
    buffer_load_dwordx4 a[136:139], v1, s[44:47], s84 offen offset:2048 sc1
    buffer_load_dwordx4 a[168:171], v1, s[44:47], s84 offen offset:3072 sc1
    s_add_u32 s84, s84, 4096
    buffer_load_dwordx4 a[200:203], v1, s[28:31], s84 offen offset:0 sc1
    buffer_load_dwordx4 a[232:235], v1, s[28:31], s84 offen offset:1024 sc1
    buffer_load_dwordx4 a[28:31], v1, s[28:31], s84 offen offset:2048 sc1
    buffer_load_dwordx4 a[60:63], v1, s[28:31], s84 offen offset:3072 sc1
    s_add_u32 s84, s84, 4096
    buffer_load_dwordx4 a[92:95], v1, s[28:31], s84 offen offset:0 sc1
    buffer_load_dwordx4 a[124:127], v1, s[28:31], s84 offen offset:1024 sc1
    buffer_load_dwordx4 a[128:131], v1, s[28:31], s84 offen offset:2048 sc1
    buffer_load_dwordx4 a[160:163], v1, s[28:31], s84 offen offset:3072 sc1
    s_add_u32 s84, s84, 4096
    buffer_load_dwordx4 a[192:195], v1, s[28:31], s84 offen offset:0 sc1
    buffer_load_dwordx4 a[224:227], v1, s[28:31], s84 offen offset:1024 sc1
    s_mov_b32 s74, 0
    v_subrev_u32 v10, 81920, v10
    s_lshl_b32 s86, s74, 3
    s_add_u32 s86, s86, s50
    s_mul_i32 s86, s86, 112
    s_mul_i32 s87, s49, 28
    s_add_u32 s86, s86, s87
    s_lshl_b32 s86, s86, 7
    s_and_b32 s87, s52, 2
    s_lshl_b32 s87, s87, 5
    s_add_u32 s86, s86, s87
    s_add_u32 s73, s86, 626688
    s_lshl_b32 s86, s74, 5
    s_add_u32 s86, s86, s52
    s_mul_i32 s87, s86, 57344
    s_mul_i32 s88, s49, 14336
    s_add_u32 s87, s87, s88
    s_add_u32 s75, s87, 24117248
    s_mul_i32 s88, s53, 2560
    s_mul_i32 s89, s49, 640
    s_add_u32 s88, s88, s89
    s_mul_i32 s87, s86, 20480
    s_add_u32 s87, s87, s88
    s_add_u32 s78, s87, 14680064
    s_add_u32 s80, s87, 20578304
    s_and_b32 s86, s86, 127
    s_mul_i32 s87, s86, 20480
    s_mul_i32 s88, s53, 160
    s_add_u32 s6, s87, s88
    s_cmp_ge_u32 s74, 4
    s_cselect_b32 s80, s6, s80
    s_mov_b32 s56, s44
    s_mov_b32 s57, s45
    s_cselect_b32 s58, 0, s46
    s_cselect_b32 s42, 2621440, 0
    s_cselect_b32 s10, 41943040, 0
    s_waitcnt vmcnt(21)
    s_mov_b64 exec, 1
    buffer_store_dword v15, off, s[44:47], s76 sc1
    s_mov_b64 exec, -1
    s_mov_b32 s69, 65536
POLL_3:
    buffer_load_dword v14, v9, s[44:47], s73 offen sc1
    s_waitcnt vmcnt(0)
    v_cmp_ne_u32 vcc, s48, v14
    s_cbranch_vccz PDONE_4
    s_sub_u32 s69, s69, 1
    s_cbranch_scc0 POLL_3
PDONE_4:
    s_mov_b32 m0, s83
    s_nop 0
    buffer_load_dwordx4 v1, s[44:47], s75 offen offset:0 sc1 lds
    buffer_load_dwordx4 v1, s[44:47], s75 offen offset:1024 sc1 lds
    buffer_load_dwordx4 v1, s[44:47], s75 offen offset:2048 sc1 lds
    buffer_load_dwordx4 v1, s[44:47], s75 offen offset:3072 sc1 lds
    s_add_u32 m0, m0, 4096
    s_add_u32 s75, s75, 4096
    buffer_load_dwordx4 v1, s[44:47], s75 offen offset:0 sc1 lds
    buffer_load_dwordx4 v1, s[44:47], s75 offen offset:1024 sc1 lds
    buffer_load_dwordx4 v1, s[44:47], s75 offen offset:2048 sc1 lds
    buffer_load_dwordx4 v1, s[44:47], s75 offen offset:3072 sc1 lds
    s_add_u32 m0, m0, 4096
    s_add_u32 s75, s75, 4096
    buffer_load_dwordx4 v1, s[44:47], s75 offen offset:0 sc1 lds
    buffer_load_dwordx4 v1, s[44:47], s75 offen offset:1024 sc1 lds
    buffer_load_dwordx4 v1, s[44:47], s75 offen offset:2048 sc1 lds
    buffer_load_dwordx4 v1, s[44:47], s75 offen offset:3072 sc1 lds
    s_add_u32 m0, m0, 4096
    s_add_u32 s75, s75, s33
    buffer_load_dwordx4 v1, s[44:47], s75 offen offset:0 sc1 lds
    buffer_load_dwordx4 v1, s[44:47], s75 offen offset:1024 sc1 lds
    s_add_u32 m0, s83, 14336
    s_mov_b32 exec_hi, 0xff
    buffer_load_dwordx4 v1, s[8:11], s78 offen sc1 lds
    s_mov_b32 exec_hi, -1
    s_mul_i32 s86, s54, 20480
    s_add_u32 s35, s86, 19922944
    s_add_u32 s71, s76, 16384
    s_mov_b32 s68, 4
    s_mov_b32 s62, 0
    s_waitcnt vmcnt(0)
    s_branch LN2_G
LN2_LOOP:
    s_mov_b32 s68, s74
    s_mov_b32 s62, 41943040
    s_add_u32 s74, s74, 1
    s_add_u32 s80, s80, 655360
    s_cmp_ge_u32 s74, 4
    s_cselect_b32 s80, s6, s80
    s_mov_b32 s56, s44
    s_mov_b32 s57, s45
    s_cselect_b32 s58, 0, s46
    s_cselect_b32 s42, 2621440, 0
    s_cselect_b32 s10, 41943040, 0
    s_waitcnt vmcnt(2)
    v_cmp_ne_u32 vcc, s48, v14
    s_cbranch_vccnz SPIN_5
SRET_6:
    s_mov_b32 m0, s83
    s_nop 0
    buffer_load_dwordx4 v1, s[44:47], s75 offen offset:0 sc1 lds
    v_lshlrev_b32 v72, 16, v152
    v_and_b32 v73, s15, v152
    v_lshlrev_b32 v74, 16, v153
    v_and_b32 v75, s15, v153
    buffer_load_dwordx4 v1, s[44:47], s75 offen offset:1024 sc1 lds
    v_lshlrev_b32 v76, 16, v154
    v_and_b32 v77, s15, v154
    v_lshlrev_b32 v78, 16, v155
    v_and_b32 v79, s15, v155
    buffer_load_dwordx4 v1, s[44:47], s75 offen offset:2048 sc1 lds
    v_lshlrev_b32 v80, 16, v156
    v_and_b32 v81, s15, v156
    v_lshlrev_b32 v82, 16, v157
    v_and_b32 v83, s15, v157
    buffer_load_dwordx4 v1, s[44:47], s75 offen offset:3072 sc1 lds
    v_lshlrev_b32 v84, 16, v158
    v_and_b32 v85, s15, v158
    v_lshlrev_b32 v86, 16, v159
    v_and_b32 v87, s15, v159
    s_add_u32 m0, m0, 4096
    s_add_u32 s75, s75, 4096
    buffer_load_dwordx4 v1, s[44:47], s75 offen offset:0 sc1 lds
    v_lshlrev_b32 v88, 16, v160
    v_and_b32 v89, s15, v160
    v_lshlrev_b32 v90, 16, v161
    v_and_b32 v91, s15, v161
    buffer_load_dwordx4 v1, s[44:47], s75 offen offset:1024 sc1 lds
    v_lshlrev_b32 v92, 16, v162
    v_and_b32 v93, s15, v162
    v_lshlrev_b32 v94, 16, v163
    v_and_b32 v95, s15, v163
    buffer_load_dwordx4 v[16:19], v2, s[44:47], s35 offen sc1
    buffer_load_dwordx4 v[20:23], v3, s[44:47], s35 offen sc1
    buffer_load_dwordx4 v[24:27], v4, s[44:47], s35 offen sc1
    buffer_load_dwordx4 v[28:31], v5, s[44:47], s35 offen sc1
    buffer_load_dwordx4 v[48:51], v6, s[44:47], s35 offen sc1
    buffer_load_dwordx4 v1, s[44:47], s75 offen offset:2048 sc1 lds
    v_lshlrev_b32 v96, 16, v164
    v_and_b32 v97, s15, v164
    v_lshlrev_b32 v98, 16, v165
    v_and_b32 v99, s15, v165
    buffer_load_dwordx4 v1, s[44:47], s75 offen offset:3072 sc1 lds
    v_lshlrev_b32 v100, 16, v166
    v_and_b32 v101, s15, v166
    v_lshlrev_b32 v102, 16, v167
    v_and_b32 v103, s15, v167
    s_add_u32 m0, m0, 4096
    s_add_u32 s75, s75, 4096
    buffer_load_dwordx4 v1, s[44:47], s75 offen offset:0 sc1 lds
    v_lshlrev_b32 v104, 16, v168
    v_and_b32 v105, s15, v168
    v_lshlrev_b32 v106, 16, v169
    v_and_b32 v107, s15, v169
    buffer_load_dwordx4 v1, s[44:47], s75 offen offset:1024 sc1 lds
    v_lshlrev_b32 v108, 16, v170
    v_and_b32 v109, s15, v170
    v_lshlrev_b32 v110, 16, v171
    v_and_b32 v111, s15, v171
    buffer_load_dwordx4 v1, s[44:47], s75 offen offset:2048 sc1 lds
    v_pk_mov_b32 v[152:153], v[172:173], v[172:173] op_sel:[0,1]
    v_pk_mov_b32 v[154:155], v[174:175], v[174:175] op_sel:[0,1]
    v_pk_mov_b32 v[156:157], v[176:177], v[176:177] op_sel:[0,1]
    v_pk_mov_b32 v[158:159], v[178:179], v[178:179] op_sel:[0,1]
    buffer_load_dwordx4 v1, s[44:47], s75 offen offset:3072 sc1 lds
    v_pk_mov_b32 v[160:161], v[180:181], v[180:181] op_sel:[0,1]
    v_pk_mov_b32 v[162:163], v[182:183], v[182:183] op_sel:[0,1]
    v_pk_mov_b32 v[164:165], v[184:185], v[184:185] op_sel:[0,1]
    v_pk_mov_b32 v[166:167], v[186:187], v[186:187] op_sel:[0,1]
    s_add_u32 m0, m0, 4096
    s_add_u32 s75, s75, s33
    buffer_load_dwordx4 v1, s[44:47], s75 offen offset:0 sc1 lds
    v_pk_mov_b32 v[168:169], v[188:189], v[188:189] op_sel:[0,1]
    v_pk_mov_b32 v[170:171], v[190:191], v[190:191] op_sel:[0,1]
    v_pk_mov_b32 v[172:173], v[192:193], v[192:193] op_sel:[0,1]
    v_pk_mov_b32 v[174:175], v[194:195], v[194:195] op_sel:[0,1]
    buffer_load_dwordx4 v1, s[44:47], s75 offen offset:1024 sc1 lds
    v_pk_mov_b32 v[176:177], v[196:197], v[196:197] op_sel:[0,1]
    v_pk_mov_b32 v[178:179], v[198:199], v[198:199] op_sel:[0,1]
    v_pk_mov_b32 v[180:181], v[200:201], v[200:201] op_sel:[0,1]
    v_pk_mov_b32 v[182:183], v[202:203], v[202:203] op_sel:[0,1]
    s_add_u32 m0, s83, 14336
    s_mov_b32 exec_hi, 0xff
    buffer_load_dwordx4 v1, s[8:11], s78 offen sc1 lds
    s_mov_b32 exec_hi, -1
    v_pk_mov_b32 v[184:185], v[204:205], v[204:205] op_sel:[0,1]
    v_pk_mov_b32 v[186:187], v[206:207], v[206:207] op_sel:[0,1]
    v_pk_mov_b32 v[188:189], v[208:209], v[208:209] op_sel:[0,1]
    v_pk_mov_b32 v[190:191], v[210:211], v[210:211] op_sel:[0,1]
    v_pk_mov_b32 v[192:193], v[212:213], v[212:213] op_sel:[0,1]
    v_pk_mov_b32 v[194:195], v[214:215], v[214:215] op_sel:[0,1]
    v_pk_mov_b32 v[196:197], v[216:217], v[216:217] op_sel:[0,1]
    v_pk_mov_b32 v[198:199], v[218:219], v[218:219] op_sel:[0,1]
    v_pk_mov_b32 v[200:201], v[220:221], v[220:221] op_sel:[0,1]
    v_pk_mov_b32 v[202:203], v[222:223], v[222:223] op_sel:[0,1]
    v_pk_mov_b32 v[204:205], v[224:225], v[224:225] op_sel:[0,1]
    v_pk_mov_b32 v[206:207], v[226:227], v[226:227] op_sel:[0,1]
    v_pk_mov_b32 v[208:209], v[228:229], v[228:229] op_sel:[0,1]
    v_pk_mov_b32 v[210:211], v[230:231], v[230:231] op_sel:[0,1]
    s_waitcnt vmcnt(9)
    v_max3_u32 v64, v16, v17, v18
    v_max3_u32 v65, v26, v27, v28
    v_max3_u32 v64, v64, v19, v20
    v_max3_u32 v65, v65, v29, v30
    v_max3_u32 v64, v64, v21, v22
    v_max3_u32 v65, v65, v31, v48
    v_max3_u32 v64, v64, v23, v24
    v_max3_u32 v65, v65, v49, v50
    v_max3_u32 v64, v64, v25, v51
    v_max_u32 v64, v64, v65
    v_cmp_eq_u32 vcc, -1, v64
    s_cbranch_vccnz F_RETRY
F_OK:
    v_lshlrev_b32 v64, 16, v16
    v_and_b32 v65, s15, v16
    v_pk_add_f32 v[72:73], v[72:73], v[64:65]
    v_lshlrev_b32 v66, 16, v17
    v_and_b32 v67, s15, v17
    v_pk_add_f32 v[74:75], v[74:75], v[66:67]
    v_lshlrev_b32 v64, 16, v18
    v_and_b32 v65, s15, v18
    v_pk_mul_f32 v[60:61], v[72:73], v[72:73]
    v_pk_add_f32 v[76:77], v[76:77], v[64:65]
    v_lshlrev_b32 v66, 16, v19
    v_and_b32 v67, s15, v19
    v_pk_mul_f32 v[62:63], v[74:75], v[74:75]
    v_pk_add_f32 v[56:57], v[72:73], v[74:75]
    v_pk_add_f32 v[78:79], v[78:79], v[66:67]
    v_lshlrev_b32 v64, 16, v20
    v_and_b32 v65, s15, v20
    v_pk_fma_f32 v[60:61], v[76:77], v[76:77], v[60:61]
    v_pk_add_f32 v[80:81], v[80:81], v[64:65]
    v_lshlrev_b32 v66, 16, v21
    v_and_b32 v67, s15, v21
    v_pk_fma_f32 v[62:63], v[78:79], v[78:79], v[62:63]
    v_pk_add_f32 v[58:59], v[76:77], v[78:79]
    v_pk_add_f32 v[82:83], v[82:83], v[66:67]
    v_lshlrev_b32 v64, 16, v22
    v_and_b32 v65, s15, v22
    v_pk_fma_f32 v[60:61], v[80:81], v[80:81], v[60:61]
    v_pk_add_f32 v[56:57], v[56:57], v[80:81]
    v_pk_add_f32 v[84:85], v[84:85], v[64:65]
    v_lshlrev_b32 v66, 16, v23
    v_and_b32 v67, s15, v23
    v_pk_fma_f32 v[62:63], v[82:83], v[82:83], v[62:63]
    v_pk_add_f32 v[58:59], v[58:59], v[82:83]
    v_pk_add_f32 v[86:87], v[86:87], v[66:67]
    v_lshlrev_b32 v64, 16, v24
    v_and_b32 v65, s15, v24
    v_pk_fma_f32 v[60:61], v[84:85], v[84:85], v[60:61]
    v_pk_add_f32 v[56:57], v[56:57], v[84:85]
    v_pk_add_f32 v[88:89], v[88:89], v[64:65]
    v_lshlrev_b32 v66, 16, v25
    v_and_b32 v67, s15, v25
    v_pk_fma_f32 v[62:63], v[86:87], v[86:87], v[62:63]
    v_pk_add_f32 v[58:59], v[58:59], v[86:87]
    v_pk_add_f32 v[90:91], v[90:91], v[66:67]
    v_lshlrev_b32 v64, 16, v26
    v_and_b32 v65, s15, v26
    v_pk_fma_f32 v[60:61], v[88:89], v[88:89], v[60:61]
    v_pk_add_f32 v[56:57], v[56:57], v[88:89]
    v_pk_add_f32 v[92:93], v[92:93], v[64:65]
    v_lshlrev_b32 v66, 16, v27
    v_and_b32 v67, s15, v27
    v_pk_fma_f32 v[62:63], v[90:91], v[90:91], v[62:63]
    v_pk_add_f32 v[58:59], v[58:59], v[90:91]
    v_pk_add_f32 v[94:95], v[94:95], v[66:67]
    v_lshlrev_b32 v64, 16, v28
    v_and_b32 v65, s15, v28
    v_pk_fma_f32 v[60:61], v[92:93], v[92:93], v[60:61]
    v_pk_add_f32 v[56:57], v[56:57], v[92:93]
    v_pk_add_f32 v[96:97], v[96:97], v[64:65]
    v_lshlrev_b32 v66, 16, v29
    v_and_b32 v67, s15, v29
    v_pk_fma_f32 v[62:63], v[94:95], v[94:95], v[62:63]
    v_pk_add_f32 v[58:59], v[58:59], v[94:95]
    v_pk_add_f32 v[98:99], v[98:99], v[66:67]
    v_lshlrev_b32 v64, 16, v30
    v_and_b32 v65, s15, v30
    v_pk_fma_f32 v[60:61], v[96:97], v[96:97], v[60:61]
    v_pk_add_f32 v[56:57], v[56:57], v[96:97]
    v_pk_add_f32 v[100:101], v[100:101], v[64:65]
    v_lshlrev_b32 v66, 16, v31
    v_and_b32 v67, s15, v31
    v_pk_fma_f32 v[62:63], v[98:99], v[98:99], v[62:63]
    v_pk_add_f32 v[58:59], v[58:59], v[98:99]
    v_pk_add_f32 v[102:103], v[102:103], v[66:67]
    v_lshlrev_b32 v64, 16, v48
    v_and_b32 v65, s15, v48
    v_pk_fma_f32 v[60:61], v[100:101], v[100:101], v[60:61]
    v_pk_add_f32 v[56:57], v[56:57], v[100:101]
    v_pk_add_f32 v[104:105], v[104:105], v[64:65]
    v_lshlrev_b32 v66, 16, v49
    v_and_b32 v67, s15, v49
    v_pk_fma_f32 v[62:63], v[102:103], v[102:103], v[62:63]
    v_pk_add_f32 v[58:59], v[58:59], v[102:103]
    v_pk_add_f32 v[106:107], v[106:107], v[66:67]
    v_lshlrev_b32 v64, 16, v50
    v_and_b32 v65, s15, v50
    v_pk_fma_f32 v[60:61], v[104:105], v[104:105], v[60:61]
    v_pk_add_f32 v[56:57], v[56:57], v[104:105]
    v_pk_add_f32 v[108:109], v[108:109], v[64:65]
    v_lshlrev_b32 v66, 16, v51
    v_and_b32 v67, s15, v51
    v_pk_fma_f32 v[62:63], v[106:107], v[106:107], v[62:63]
    v_pk_add_f32 v[58:59], v[58:59], v[106:107]
    v_pk_add_f32 v[110:111], v[110:111], v[66:67]
    v_pk_fma_f32 v[60:61], v[108:109], v[108:109], v[60:61]
    v_pk_add_f32 v[56:57], v[56:57], v[108:109]
    v_pk_fma_f32 v[62:63], v[110:111], v[110:111], v[62:63]
    v_pk_add_f32 v[58:59], v[58:59], v[110:111]
    v_pk_add_f32 v[56:57], v[56:57], v[58:59]
    v_pk_add_f32 v[60:61], v[60:61], v[62:63]
    v_add_f32 v56, v56, v57
    v_add_f32 v60, v60, v61
    s_nop 0
    v_add_f32_dpp v56, v56, v56 row_ror:8 row_mask:0xf bank_mask:0xf
    v_add_f32_dpp v60, v60, v60 row_ror:8 row_mask:0xf bank_mask:0xf
    s_nop 0
    v_add_f32_dpp v56, v56, v56 row_ror:4 row_mask:0xf bank_mask:0xf
    v_add_f32_dpp v60, v60, v60 row_ror:4 row_mask:0xf bank_mask:0xf
    s_nop 0
    v_add_f32_dpp v56, v56, v56 row_ror:2 row_mask:0xf bank_mask:0xf
    v_add_f32_dpp v60, v60, v60 row_ror:2 row_mask:0xf bank_mask:0xf
    s_nop 0
    v_add_f32_dpp v56, v56, v56 row_ror:1 row_mask:0xf bank_mask:0xf
    v_add_f32_dpp v60, v60, v60 row_ror:1 row_mask:0xf bank_mask:0xf
    v_mul_f32 v56, 0x3acccccd, v56
    v_mul_f32 v57, v56, v56
    v_fma_f32 v57, v60, s7, -v57
    v_max_f32 v57, 0, v57
    v_add_f32 v57, 0x3727c5ac, v57
    v_rsq_f32 v68, v57
    s_nop 0
    v_mul_f32 v70, v56, v68
    v_pk_fma_f32 v[64:65], v[72:73], v[68:69], v[70:71] op_sel_hi:[1,0,0] neg_lo:[0,0,1] neg_hi:[0,0,1]
    v_pk_fma_f32 v[72:73], v[112:113], v[64:65], v[72:73]
    v_pk_fma_f32 v[66:67], v[74:75], v[68:69], v[70:71] op_sel_hi:[1,0,0] neg_lo:[0,0,1] neg_hi:[0,0,1]
    v_pk_fma_f32 v[74:75], v[114:115], v[66:67], v[74:75]
    v_pk_fma_f32 v[64:65], v[76:77], v[68:69], v[70:71] op_sel_hi:[1,0,0] neg_lo:[0,0,1] neg_hi:[0,0,1]
    v_pk_mul_f32 v[60:61], v[72:73], v[72:73]
    v_pk_fma_f32 v[76:77], v[116:117], v[64:65], v[76:77]
    v_pk_fma_f32 v[66:67], v[78:79], v[68:69], v[70:71] op_sel_hi:[1,0,0] neg_lo:[0,0,1] neg_hi:[0,0,1]
    v_pk_mul_f32 v[62:63], v[74:75], v[74:75]
    v_pk_add_f32 v[56:57], v[72:73], v[74:75]
    v_pk_fma_f32 v[78:79], v[118:119], v[66:67], v[78:79]
    v_pk_fma_f32 v[64:65], v[80:81], v[68:69], v[70:71] op_sel_hi:[1,0,0] neg_lo:[0,0,1] neg_hi:[0,0,1]
    v_pk_fma_f32 v[60:61], v[76:77], v[76:77], v[60:61]
    v_pk_fma_f32 v[80:81], v[120:121], v[64:65], v[80:81]
    v_pk_fma_f32 v[66:67], v[82:83], v[68:69], v[70:71] op_sel_hi:[1,0,0] neg_lo:[0,0,1] neg_hi:[0,0,1]
    v_pk_fma_f32 v[62:63], v[78:79], v[78:79], v[62:63]
    v_pk_add_f32 v[58:59], v[76:77], v[78:79]
    v_pk_fma_f32 v[82:83], v[122:123], v[66:67], v[82:83]
    v_pk_fma_f32 v[64:65], v[84:85], v[68:69], v[70:71] op_sel_hi:[1,0,0] neg_lo:[0,0,1] neg_hi:[0,0,1]
    v_pk_fma_f32 v[60:61], v[80:81], v[80:81], v[60:61]
    v_pk_add_f32 v[56:57], v[56:57], v[80:81]
    v_pk_fma_f32 v[84:85], v[124:125], v[64:65], v[84:85]
    v_pk_fma_f32 v[66:67], v[86:87], v[68:69], v[70:71] op_sel_hi:[1,0,0] neg_lo:[0,0,1] neg_hi:[0,0,1]
    v_pk_fma_f32 v[62:63], v[82:83], v[82:83], v[62:63]
    v_pk_add_f32 v[58:59], v[58:59], v[82:83]
    v_pk_fma_f32 v[86:87], v[126:127], v[66:67], v[86:87]
    v_pk_fma_f32 v[64:65], v[88:89], v[68:69], v[70:71] op_sel_hi:[1,0,0] neg_lo:[0,0,1] neg_hi:[0,0,1]
    v_pk_fma_f32 v[60:61], v[84:85], v[84:85], v[60:61]
    v_pk_add_f32 v[56:57], v[56:57], v[84:85]
    v_pk_fma_f32 v[88:89], v[128:129], v[64:65], v[88:89]
    v_pk_fma_f32 v[66:67], v[90:91], v[68:69], v[70:71] op_sel_hi:[1,0,0] neg_lo:[0,0,1] neg_hi:[0,0,1]
    v_pk_fma_f32 v[62:63], v[86:87], v[86:87], v[62:63]
    v_pk_add_f32 v[58:59], v[58:59], v[86:87]
    v_pk_fma_f32 v[90:91], v[130:131], v[66:67], v[90:91]
    v_pk_fma_f32 v[64:65], v[92:93], v[68:69], v[70:71] op_sel_hi:[1,0,0] neg_lo:[0,0,1] neg_hi:[0,0,1]
    v_pk_fma_f32 v[60:61], v[88:89], v[88:89], v[60:61]
    v_pk_add_f32 v[56:57], v[56:57], v[88:89]
    v_pk_fma_f32 v[92:93], v[132:133], v[64:65], v[92:93]
    v_pk_fma_f32 v[66:67], v[94:95], v[68:69], v[70:71] op_sel_hi:[1,0,0] neg_lo:[0,0,1] neg_hi:[0,0,1]
    v_pk_fma_f32 v[62:63], v[90:91], v[90:91], v[62:63]
    v_pk_add_f32 v[58:59], v[58:59], v[90:91]
    v_pk_fma_f32 v[94:95], v[134:135], v[66:67], v[94:95]
    v_pk_fma_f32 v[64:65], v[96:97], v[68:69], v[70:71] op_sel_hi:[1,0,0] neg_lo:[0,0,1] neg_hi:[0,0,1]
    v_pk_fma_f32 v[60:61], v[92:93], v[92:93], v[60:61]
    v_pk_add_f32 v[56:57], v[56:57], v[92:93]
    v_pk_fma_f32 v[96:97], v[136:137], v[64:65], v[96:97]
    v_pk_fma_f32 v[66:67], v[98:99], v[68:69], v[70:71] op_sel_hi:[1,0,0] neg_lo:[0,0,1] neg_hi:[0,0,1]
    v_pk_fma_f32 v[62:63], v[94:95], v[94:95], v[62:63]
    v_pk_add_f32 v[58:59], v[58:59], v[94:95]
    v_pk_fma_f32 v[98:99], v[138:139], v[66:67], v[98:99]
    v_pk_fma_f32 v[64:65], v[100:101], v[68:69], v[70:71] op_sel_hi:[1,0,0] neg_lo:[0,0,1] neg_hi:[0,0,1]
    v_pk_fma_f32 v[60:61], v[96:97], v[96:97], v[60:61]
    v_pk_add_f32 v[56:57], v[56:57], v[96:97]
    v_pk_fma_f32 v[100:101], v[140:141], v[64:65], v[100:101]
    v_pk_fma_f32 v[66:67], v[102:103], v[68:69], v[70:71] op_sel_hi:[1,0,0] neg_lo:[0,0,1] neg_hi:[0,0,1]
    v_pk_fma_f32 v[62:63], v[98:99], v[98:99], v[62:63]
    v_pk_add_f32 v[58:59], v[58:59], v[98:99]
    v_pk_fma_f32 v[102:103], v[142:143], v[66:67], v[102:103]
    v_pk_fma_f32 v[64:65], v[104:105], v[68:69], v[70:71] op_sel_hi:[1,0,0] neg_lo:[0,0,1] neg_hi:[0,0,1]
    v_pk_fma_f32 v[60:61], v[100:101], v[100:101], v[60:61]
    v_pk_add_f32 v[56:57], v[56:57], v[100:101]
    v_pk_fma_f32 v[104:105], v[144:145], v[64:65], v[104:105]
    v_pk_fma_f32 v[66:67], v[106:107], v[68:69], v[70:71] op_sel_hi:[1,0,0] neg_lo:[0,0,1] neg_hi:[0,0,1]
    v_pk_fma_f32 v[62:63], v[102:103], v[102:103], v[62:63]
    v_pk_add_f32 v[58:59], v[58:59], v[102:103]
    v_pk_fma_f32 v[106:107], v[146:147], v[66:67], v[106:107]
    v_pk_fma_f32 v[64:65], v[108:109], v[68:69], v[70:71] op_sel_hi:[1,0,0] neg_lo:[0,0,1] neg_hi:[0,0,1]
    v_pk_fma_f32 v[60:61], v[104:105], v[104:105], v[60:61]
    v_pk_add_f32 v[56:57], v[56:57], v[104:105]
    v_pk_fma_f32 v[108:109], v[148:149], v[64:65], v[108:109]
    v_pk_fma_f32 v[66:67], v[110:111], v[68:69], v[70:71] op_sel_hi:[1,0,0] neg_lo:[0,0,1] neg_hi:[0,0,1]
    v_pk_fma_f32 v[62:63], v[106:107], v[106:107], v[62:63]
    v_pk_add_f32 v[58:59], v[58:59], v[106:107]
    v_pk_fma_f32 v[110:111], v[150:151], v[66:67], v[110:111]
    v_pk_fma_f32 v[60:61], v[108:109], v[108:109], v[60:61]
    v_pk_add_f32 v[56:57], v[56:57], v[108:109]
    v_pk_fma_f32 v[62:63], v[110:111], v[110:111], v[62:63]
    v_pk_add_f32 v[58:59], v[58:59], v[110:111]
    v_pk_add_f32 v[56:57], v[56:57], v[58:59]
    v_pk_add_f32 v[60:61], v[60:61], v[62:63]
    v_cvt_pk_bf16_f32 v128, v72, v73
    v_add_f32 v56, v56, v57
    v_add_f32 v60, v60, v61
    v_cvt_pk_bf16_f32 v129, v74, v75
    v_cvt_pk_bf16_f32 v130, v76, v77
    v_add_f32_dpp v56, v56, v56 row_ror:8 row_mask:0xf bank_mask:0xf
    v_add_f32_dpp v60, v60, v60 row_ror:8 row_mask:0xf bank_mask:0xf
    v_cvt_pk_bf16_f32 v131, v78, v79
    v_cvt_pk_bf16_f32 v132, v80, v81
    v_add_f32_dpp v56, v56, v56 row_ror:4 row_mask:0xf bank_mask:0xf
    v_add_f32_dpp v60, v60, v60 row_ror:4 row_mask:0xf bank_mask:0xf
    v_cvt_pk_bf16_f32 v133, v82, v83
    v_cvt_pk_bf16_f32 v134, v84, v85
    v_add_f32_dpp v56, v56, v56 row_ror:2 row_mask:0xf bank_mask:0xf
    v_add_f32_dpp v60, v60, v60 row_ror:2 row_mask:0xf bank_mask:0xf
    v_cvt_pk_bf16_f32 v135, v86, v87
    v_cvt_pk_bf16_f32 v136, v88, v89
    v_add_f32_dpp v56, v56, v56 row_ror:1 row_mask:0xf bank_mask:0xf
    v_add_f32_dpp v60, v60, v60 row_ror:1 row_mask:0xf bank_mask:0xf
    v_cvt_pk_bf16_f32 v137, v90, v91
    v_mul_f32 v56, 0x3acccccd, v56
    v_cvt_pk_bf16_f32 v138, v92, v93
    v_cvt_pk_bf16_f32 v139, v94, v95
    v_mul_f32 v57, v56, v56
    v_cvt_pk_bf16_f32 v140, v96, v97
    v_cvt_pk_bf16_f32 v141, v98, v99
    v_fma_f32 v57, v60, s7, -v57
    v_cvt_pk_bf16_f32 v142, v100, v101
    v_cvt_pk_bf16_f32 v143, v102, v103
    v_max_f32 v57, 0, v57
    v_cvt_pk_bf16_f32 v144, v104, v105
    v_cvt_pk_bf16_f32 v145, v106, v107
    v_add_f32 v57, 0x3727c5ac, v57
    v_cvt_pk_bf16_f32 v146, v108, v109
    v_cvt_pk_bf16_f32 v147, v110, v111
    v_rsq_f32 v58, v57
    s_nop 0
    v_mul_f32 v58, 0x3eeff558, v58
    v_mul_f32 v56, v56, v58
    s_add_u32 s86, s81, 4096
    s_add_u32 s87, s81, 8192
    v_pk_fma_f32 v[112:113], v[72:73], v[58:59], v[56:57] op_sel_hi:[1,0,0] neg_lo:[0,0,1] neg_hi:[0,0,1]
    v_pk_fma_f32 v[114:115], v[74:75], v[58:59], v[56:57] op_sel_hi:[1,0,0] neg_lo:[0,0,1] neg_hi:[0,0,1]
    v_pk_fma_f32 v[116:117], v[76:77], v[58:59], v[56:57] op_sel_hi:[1,0,0] neg_lo:[0,0,1] neg_hi:[0,0,1]
    v_cvt_pk_bf16_f32 v36, v112, v113
    v_pk_fma_f32 v[118:119], v[78:79], v[58:59], v[56:57] op_sel_hi:[1,0,0] neg_lo:[0,0,1] neg_hi:[0,0,1]
    v_cvt_pk_bf16_f32 v37, v114, v115
    v_pk_fma_f32 v[120:121], v[80:81], v[58:59], v[56:57] op_sel_hi:[1,0,0] neg_lo:[0,0,1] neg_hi:[0,0,1]
    v_cvt_pk_bf16_f32 v38, v116, v117
    v_pk_fma_f32 v[122:123], v[82:83], v[58:59], v[56:57] op_sel_hi:[1,0,0] neg_lo:[0,0,1] neg_hi:[0,0,1]
    v_cvt_pk_bf16_f32 v39, v118, v119
    v_pk_fma_f32 v[124:125], v[84:85], v[58:59], v[56:57] op_sel_hi:[1,0,0] neg_lo:[0,0,1] neg_hi:[0,0,1]
    v_cvt_pk_bf16_f32 v40, v120, v121
    buffer_store_dwordx4 v[36:39], v8, s[44:47], s81 offen offset:0 sc1
    v_pk_fma_f32 v[126:127], v[86:87], v[58:59], v[56:57] op_sel_hi:[1,0,0] neg_lo:[0,0,1] neg_hi:[0,0,1]
    v_cvt_pk_bf16_f32 v41, v122, v123
    v_pk_fma_f32 v[112:113], v[88:89], v[58:59], v[56:57] op_sel_hi:[1,0,0] neg_lo:[0,0,1] neg_hi:[0,0,1]
    v_cvt_pk_bf16_f32 v42, v124, v125
    v_pk_fma_f32 v[114:115], v[90:91], v[58:59], v[56:57] op_sel_hi:[1,0,0] neg_lo:[0,0,1] neg_hi:[0,0,1]
    v_cvt_pk_bf16_f32 v43, v126, v127
    v_pk_fma_f32 v[116:117], v[92:93], v[58:59], v[56:57] op_sel_hi:[1,0,0] neg_lo:[0,0,1] neg_hi:[0,0,1]
    v_cvt_pk_bf16_f32 v44, v112, v113
    buffer_store_dwordx4 v[40:43], v8, s[44:47], s81 offen offset:2048 sc1
    v_pk_fma_f32 v[118:119], v[94:95], v[58:59], v[56:57] op_sel_hi:[1,0,0] neg_lo:[0,0,1] neg_hi:[0,0,1]
    v_cvt_pk_bf16_f32 v45, v114, v115
    v_pk_fma_f32 v[120:121], v[96:97], v[58:59], v[56:57] op_sel_hi:[1,0,0] neg_lo:[0,0,1] neg_hi:[0,0,1]
    v_cvt_pk_bf16_f32 v46, v116, v117
    v_pk_fma_f32 v[122:123], v[98:99], v[58:59], v[56:57] op_sel_hi:[1,0,0] neg_lo:[0,0,1] neg_hi:[0,0,1]
    v_cvt_pk_bf16_f32 v47, v118, v119
    v_pk_fma_f32 v[124:125], v[100:101], v[58:59], v[56:57] op_sel_hi:[1,0,0] neg_lo:[0,0,1] neg_hi:[0,0,1]
    v_cvt_pk_bf16_f32 v48, v120, v121
    buffer_store_dwordx4 v[44:47], v8, s[44:47], s86 offen offset:0 sc1
    v_pk_fma_f32 v[126:127], v[102:103], v[58:59], v[56:57] op_sel_hi:[1,0,0] neg_lo:[0,0,1] neg_hi:[0,0,1]
    v_cvt_pk_bf16_f32 v49, v122, v123
    v_pk_fma_f32 v[112:113], v[104:105], v[58:59], v[56:57] op_sel_hi:[1,0,0] neg_lo:[0,0,1] neg_hi:[0,0,1]
    v_cvt_pk_bf16_f32 v50, v124, v125
    v_pk_fma_f32 v[114:115], v[106:107], v[58:59], v[56:57] op_sel_hi:[1,0,0] neg_lo:[0,0,1] neg_hi:[0,0,1]
    v_cvt_pk_bf16_f32 v51, v126, v127
    v_pk_fma_f32 v[116:117], v[108:109], v[58:59], v[56:57] op_sel_hi:[1,0,0] neg_lo:[0,0,1] neg_hi:[0,0,1]
    v_cvt_pk_bf16_f32 v52, v112, v113
    buffer_store_dwordx4 v[48:51], v8, s[44:47], s86 offen offset:2048 sc1
    v_pk_fma_f32 v[118:119], v[110:111], v[58:59], v[56:57] op_sel_hi:[1,0,0] neg_lo:[0,0,1] neg_hi:[0,0,1]
    v_cvt_pk_bf16_f32 v53, v114, v115
    v_cvt_pk_bf16_f32 v54, v116, v117
    v_cvt_pk_bf16_f32 v55, v118, v119
    buffer_store_dwordx4 v[52:55], v8, s[44:47], s87 offen offset:0 sc1
LN2_G:
    ds_read_b128 v[48:51], v7 offset:0
    ds_read_b128 v[52:55], v7 offset:1024
    s_waitcnt lgkmcnt(1)
    v_mfma_f32_16x16x32_bf16 v[16:19], v[232:235], v[48:51], 0
    ds_read_b128 v[56:59], v7 offset:2048
    v_mfma_f32_16x16x32_bf16 v[20:23], v[236:239], v[48:51], 0
    ds_read2st64_b64 v[72:75], v10 offset0:0 offset1:1
    buffer_store_dwordx4 v[128:131], v2, s[60:63], s70 offen sc1
    v_mfma_f32_16x16x32_bf16 v[24:27], v[240:243], v[48:51], 0
    ds_read2st64_b64 v[76:79], v10 offset0:8 offset1:9
    v_mfma_f32_16x16x32_bf16 v[28:31], v[244:247], v[48:51], 0
    ds_read2st64_b64 v[80:83], v10 offset0:16 offset1:17
    v_mfma_f32_16x16x32_bf16 v[60:63], v[248:251], v[48:51], 0
    buffer_store_dwordx4 v[132:135], v3, s[60:63], s70 offen sc1
    s_waitcnt lgkmcnt(4)
    v_mfma_f32_16x16x32_bf16 v[16:19], v[252:255], v[52:55], v[16:19]
    ds_read_b128 v[48:51], v7 offset:3072
    ds_read2st64_b64 v[84:87], v10 offset0:24 offset1:25
    v_mfma_f32_16x16x32_bf16 v[20:23], a[0:3], v[52:55], v[20:23]
    ds_read2st64_b64 v[88:91], v10 offset0:32 offset1:33
    v_mfma_f32_16x16x32_bf16 v[24:27], a[32:35], v[52:55], v[24:27]
    buffer_store_dwordx4 v[136:139], v4, s[60:63], s70 offen sc1
    v_mfma_f32_16x16x32_bf16 v[28:31], a[64:67], v[52:55], v[28:31]
    v_mfma_f32_16x16x32_bf16 v[60:63], a[96:99], v[52:55], v[60:63]
    s_waitcnt lgkmcnt(6)
    v_mfma_f32_16x16x32_bf16 v[16:19], a[156:159], v[56:59], v[16:19]
    ds_read_b128 v[52:55], v7 offset:4096
    buffer_store_dwordx4 v[140:143], v5, s[60:63], s70 offen sc1
    v_mfma_f32_16x16x32_bf16 v[20:23], a[188:191], v[56:59], v[20:23]
    v_mfma_f32_16x16x32_bf16 v[24:27], a[220:223], v[56:59], v[24:27]
    v_mfma_f32_16x16x32_bf16 v[28:31], a[252:255], v[56:59], v[28:31]
    buffer_store_dwordx4 v[144:147], v6, s[60:63], s70 offen sc1
    v_mfma_f32_16x16x32_bf16 v[60:63], a[4:7], v[56:59], v[60:63]
    v_add_u32 v10, 20480, v10
    s_waitcnt lgkmcnt(3)
    v_mfma_f32_16x16x32_bf16 v[16:19], a[36:39], v[48:51], v[16:19]
    ds_read_b128 v[56:59], v7 offset:5120
    v_mfma_f32_16x16x32_bf16 v[20:23], a[68:71], v[48:51], v[20:23]
    s_add_u32 s70, s70, 655360
    v_mfma_f32_16x16x32_bf16 v[24:27], a[100:103], v[48:51], v[24:27]
    s_add_u32 s81, s81, 655360
    v_mfma_f32_16x16x32_bf16 v[28:31], a[152:155], v[48:51], v[28:31]
    s_add_u32 s35, s35, 655360
    v_mfma_f32_16x16x32_bf16 v[60:63], a[184:187], v[48:51], v[60:63]
    s_add_u32 s73, s73, 114688
    s_waitcnt lgkmcnt(1)
    v_mfma_f32_16x16x32_bf16 v[16:19], a[216:219], v[52:55], v[16:19]
    s_waitcnt vmcnt(18)
    ds_read_b128 v[48:51], v7 offset:6144
    v_mfma_f32_16x16x32_bf16 v[20:23], a[248:251], v[52:55], v[20:23]
    s_add_u32 s75, s75, s34
    v_mfma_f32_16x16x32_bf16 v[24:27], a[8:11], v[52:55], v[24:27]
    s_add_u32 s78, s78, 655360
    v_mfma_f32_16x16x32_bf16 v[28:31], a[40:43], v[52:55], v[28:31]
    v_mfma_f32_16x16x32_bf16 v[60:63], a[72:75], v[52:55], v[60:63]
    s_waitcnt lgkmcnt(1)
    v_mfma_f32_16x16x32_bf16 v[16:19], a[104:107], v[56:59], v[16:19]
    s_waitcnt vmcnt(17)
    ds_read_b128 v[52:55], v7 offset:7168
    v_mfma_f32_16x16x32_bf16 v[20:23], a[148:151], v[56:59], v[20:23]
    v_mfma_f32_16x16x32_bf16 v[24:27], a[180:183], v[56:59], v[24:27]
    v_mfma_f32_16x16x32_bf16 v[28:31], a[212:215], v[56:59], v[28:31]
    v_mfma_f32_16x16x32_bf16 v[60:63], a[244:247], v[56:59], v[60:63]
    s_waitcnt lgkmcnt(1)
    v_mfma_f32_16x16x32_bf16 v[16:19], a[12:15], v[48:51], v[16:19]
    s_waitcnt vmcnt(16)
    ds_read_b128 v[56:59], v7 offset:8192
    v_mfma_f32_16x16x32_bf16 v[20:23], a[44:47], v[48:51], v[20:23]
    v_mfma_f32_16x16x32_bf16 v[24:27], a[76:79], v[48:51], v[24:27]
    v_mfma_f32_16x16x32_bf16 v[28:31], a[108:111], v[48:51], v[28:31]
    v_mfma_f32_16x16x32_bf16 v[60:63], a[144:147], v[48:51], v[60:63]
    s_waitcnt lgkmcnt(1)
    v_mfma_f32_16x16x32_bf16 v[16:19], a[176:179], v[52:55], v[16:19]
    s_waitcnt vmcnt(15)
    ds_read_b128 v[48:51], v7 offset:9216
    v_mfma_f32_16x16x32_bf16 v[20:23], a[208:211], v[52:55], v[20:23]
    v_mfma_f32_16x16x32_bf16 v[24:27], a[240:243], v[52:55], v[24:27]
    v_mfma_f32_16x16x32_bf16 v[28:31], a[16:19], v[52:55], v[28:31]
    v_mfma_f32_16x16x32_bf16 v[60:63], a[48:51], v[52:55], v[60:63]
    s_waitcnt lgkmcnt(1)
    v_mfma_f32_16x16x32_bf16 v[16:19], a[80:83], v[56:59], v[16:19]
    s_waitcnt vmcnt(14)
    ds_read_b128 v[52:55], v7 offset:10240
    v_mfma_f32_16x16x32_bf16 v[20:23], a[112:115], v[56:59], v[20:23]
    v_mfma_f32_16x16x32_bf16 v[24:27], a[140:143], v[56:59], v[24:27]
    v_mfma_f32_16x16x32_bf16 v[28:31], a[172:175], v[56:59], v[28:31]
    v_mfma_f32_16x16x32_bf16 v[60:63], a[204:207], v[56:59], v[60:63]
    s_waitcnt vmcnt(0)
    s_mov_b64 exec, 1
    buffer_store_dword v15, off, s[44:47], s76 sc1
    s_mov_b64 exec, -1
    s_mov_b32 s76, s71
    s_add_u32 s71, s71, 16384
    s_waitcnt lgkmcnt(1)
    v_mfma_f32_16x16x32_bf16 v[16:19], a[236:239], v[48:51], v[16:19]
    ds_read_b128 v[56:59], v7 offset:11264
    v_mfma_f32_16x16x32_bf16 v[20:23], a[24:27], v[48:51], v[20:23]
    v_mfma_f32_16x16x32_bf16 v[24:27], a[56:59], v[48:51], v[24:27]
    v_mfma_f32_16x16x32_bf16 v[28:31], a[88:91], v[48:51], v[28:31]
    v_mfma_f32_16x16x32_bf16 v[60:63], a[120:123], v[48:51], v[60:63]
    s_waitcnt lgkmcnt(1)
    v_mfma_f32_16x16x32_bf16 v[16:19], a[132:135], v[52:55], v[16:19]
    ds_read_b128 v[48:51], v7 offset:12288
    v_mfma_f32_16x16x32_bf16 v[20:23], a[164:167], v[52:55], v[20:23]
    v_mfma_f32_16x16x32_bf16 v[24:27], a[196:199], v[52:55], v[24:27]
    v_mfma_f32_16x16x32_bf16 v[28:31], a[228:231], v[52:55], v[28:31]
    v_mfma_f32_16x16x32_bf16 v[60:63], a[20:23], v[52:55], v[60:63]
    s_waitcnt lgkmcnt(1)
    v_mfma_f32_16x16x32_bf16 v[16:19], a[52:55], v[56:59], v[16:19]
    ds_read_b128 v[52:55], v7 offset:13312
    v_mfma_f32_16x16x32_bf16 v[20:23], a[84:87], v[56:59], v[20:23]
    v_mfma_f32_16x16x32_bf16 v[24:27], a[116:119], v[56:59], v[24:27]
    v_mfma_f32_16x16x32_bf16 v[28:31], a[136:139], v[56:59], v[28:31]
    v_mfma_f32_16x16x32_bf16 v[60:63], a[168:171], v[56:59], v[60:63]
    s_waitcnt lgkmcnt(1)
    v_mfma_f32_16x16x32_bf16 v[16:19], a[200:203], v[48:51], v[16:19]
    v_mfma_f32_16x16x32_bf16 v[20:23], a[232:235], v[48:51], v[20:23]
    s_barrier
    v_mfma_f32_16x16x32_bf16 v[24:27], a[28:31], v[48:51], v[24:27]
    v_mfma_f32_16x16x32_bf16 v[28:31], a[60:63], v[48:51], v[28:31]
    v_mfma_f32_16x16x32_bf16 v[60:63], a[92:95], v[48:51], v[60:63]
    s_waitcnt lgkmcnt(0)
    v_mfma_f32_16x16x32_bf16 v[16:19], a[124:127], v[52:55], v[16:19]
    v_mfma_f32_16x16x32_bf16 v[20:23], a[128:131], v[52:55], v[20:23]
    v_mfma_f32_16x16x32_bf16 v[24:27], a[160:163], v[52:55], v[24:27]
    s_nop 1
    ds_write_b128 v11, v[16:19] offset:0
    v_mfma_f32_16x16x32_bf16 v[28:31], a[192:195], v[52:55], v[28:31]
    s_nop 0
    ds_write_b128 v11, v[20:23] offset:64
    v_mfma_f32_16x16x32_bf16 v[60:63], a[224:227], v[52:55], v[60:63]
    s_nop 0
    ds_write_b128 v11, v[24:27] offset:128
    s_nop 2
    ds_write_b128 v11, v[28:31] offset:192
    s_nop 1
    ds_write_b128 v11, v[60:63] offset:256
    s_waitcnt lgkmcnt(0)
    buffer_load_dword v14, v9, s[44:47], s73 offen sc1
    s_barrier
    ds_read_b128 v[32:35], v12 offset:0
    ds_read_b128 v[40:43], v12 offset:5376
    ds_read_b128 v[36:39], v12 offset:16
    ds_read_b128 v[44:47], v12 offset:5392
    ds_read_b128 v[64:67], v12 offset:10752
    ds_read_b128 v[68:71], v12 offset:10768
    v_lshlrev_b32 v112, 16, v72
    v_and_b32 v113, s15, v72
    v_lshlrev_b32 v114, 16, v73
    v_and_b32 v115, s15, v73
    v_lshlrev_b32 v116, 16, v74
    v_and_b32 v117, s15, v74
    v_lshlrev_b32 v118, 16, v75
    v_and_b32 v119, s15, v75
    v_lshlrev_b32 v120, 16, v76
    v_and_b32 v121, s15, v76
    v_lshlrev_b32 v122, 16, v77
    v_and_b32 v123, s15, v77
    v_lshlrev_b32 v124, 16, v78
    v_and_b32 v125, s15, v78
    v_lshlrev_b32 v126, 16, v79
    v_and_b32 v127, s15, v79
    v_lshlrev_b32 v128, 16, v80
    v_and_b32 v129, s15, v80
    v_lshlrev_b32 v130, 16, v81
    v_and_b32 v131, s15, v81
    v_lshlrev_b32 v132, 16, v82
    v_and_b32 v133, s15, v82
    v_lshlrev_b32 v134, 16, v83
    v_and_b32 v135, s15, v83
    v_lshlrev_b32 v136, 16, v84
    v_and_b32 v137, s15, v84
    v_lshlrev_b32 v138, 16, v85
    v_and_b32 v139, s15, v85
    v_lshlrev_b32 v140, 16, v86
    v_and_b32 v141, s15, v86
    v_lshlrev_b32 v142, 16, v87
    v_and_b32 v143, s15, v87
    v_lshlrev_b32 v144, 16, v88
    v_and_b32 v145, s15, v88
    v_lshlrev_b32 v146, 16, v89
    v_and_b32 v147, s15, v89
    v_lshlrev_b32 v148, 16, v90
    v_and_b32 v149, s15, v90
    v_lshlrev_b32 v150, 16, v91
    v_and_b32 v151, s15, v91
    s_waitcnt lgkmcnt(4)
    v_pk_add_f32 v[32:33], v[32:33], v[40:41]
    v_pk_add_f32 v[34:35], v[34:35], v[42:43]
    s_waitcnt lgkmcnt(2)
    v_pk_add_f32 v[36:37], v[36:37], v[44:45]
    v_pk_add_f32 v[38:39], v[38:39], v[46:47]
    ds_read_b128 v[40:43], v12 offset:16128
    ds_read_b128 v[44:47], v12 offset:16144
    s_waitcnt lgkmcnt(3)
    v_pk_add_f32 v[32:33], v[32:33], v[64:65]
    v_pk_add_f32 v[34:35], v[34:35], v[66:67]
    s_waitcnt lgkmcnt(2)
    v_pk_add_f32 v[36:37], v[36:37], v[68:69]
    v_pk_add_f32 v[38:39], v[38:39], v[70:71]
    ds_read_b128 v[64:67], v7 offset:14336
    s_waitcnt lgkmcnt(2)
    v_pk_add_f32 v[32:33], v[32:33], v[40:41]
    v_pk_add_f32 v[34:35], v[34:35], v[42:43]
    s_waitcnt lgkmcnt(1)
    v_pk_add_f32 v[36:37], v[36:37], v[44:45]
    v_pk_add_f32 v[38:39], v[38:39], v[46:47]
    s_waitcnt lgkmcnt(0)
    v_lshlrev_b32 v68, 16, v64
    v_and_b32 v69, 0xffff0000, v64
    v_lshlrev_b32 v70, 16, v65
    v_and_b32 v71, 0xffff0000, v65
    v_pk_fma_f32 v[32:33], v[32:33], s[100:101], v[68:69] op_sel:[0,1,0] op_sel_hi:[1,1,1]
    v_pk_fma_f32 v[34:35], v[34:35], s[100:101], v[70:71] op_sel:[0,1,0] op_sel_hi:[1,1,1]
    v_cvt_pk_bf16_f32 v64, v32, v33
    v_cvt_pk_bf16_f32 v65, v34, v35
    v_lshlrev_b32 v68, 16, v66
    v_and_b32 v69, 0xffff0000, v66
    v_lshlrev_b32 v70, 16, v67
    v_and_b32 v71, 0xffff0000, v67
    v_pk_fma_f32 v[36:37], v[36:37], s[100:101], v[68:69] op_sel:[0,1,0] op_sel_hi:[1,1,1]
    v_pk_fma_f32 v[38:39], v[38:39], s[100:101], v[70:71] op_sel:[0,1,0] op_sel_hi:[1,1,1]
    v_cvt_pk_bf16_f32 v66, v36, v37
    v_cvt_pk_bf16_f32 v67, v38, v39
    s_mov_b32 exec_hi, 0xff
    buffer_store_dwordx4 v[64:67], v1, s[56:59], s80 offen sc1
    buffer_store_dwordx4 v[64:67], v13, s[40:43], s80 offen
    s_mov_b32 exec_hi, -1
    s_cmp_lt_u32 s74, 4
    s_cbranch_scc1 LN2_LOOP
    s_mov_b32 s74, 5
    s_branch G2_LOOP
R_G1:
    s_bitcmp1_b32 s98, 1
    s_cbranch_scc1 R_CONV
    s_waitcnt vmcnt(3)
    s_bitcmp1_b32 s98, 3
    s_cbranch_scc0 G1_NP
    v_lshrrev_b32 v70, 5, v0
    v_bfe_u32 v14, v0, 4, 1
    v_lshl_add_u32 v70, v70, 2, v14
    v_bfe_u32 v14, v0, 2, 2
    v_lshl_add_u32 v70, v70, 2, v14
    v_mul_u32_u24 v70, 320, v70
    v_and_b32 v14, 3, v0
    v_lshl_add_u32 v70, v14, 3, v70
    v_add_u32 v70, s82, v70
    s_mul_i32 s86, s49, 108
    s_add_u32 s86, s86, s32
    s_mul_i32 s86, s86, 5120
    s_add_u32 s86, s86, 38797312
    s_lshl_b32 s91, s32, 2
    s_add_u32 s91, s91, s49
    s_lshl_b32 s91, s91, 7
    s_add_u32 s91, s91, 593920
    ds_read_b64_tr_b16 v[136:137], v70 offset:0
    ds_read_b64_tr_b16 v[138:139], v70 offset:2560
    ds_read_b64_tr_b16 v[140:141], v70 offset:32
    ds_read_b64_tr_b16 v[142:143], v70 offset:2592
    ds_read_b64_tr_b16 v[144:145], v70 offset:64
    ds_read_b64_tr_b16 v[146:147], v70 offset:2624
    ds_read_b64_tr_b16 v[148:149], v70 offset:96
    ds_read_b64_tr_b16 v[150:151], v70 offset:2656
    ds_read_b64_tr_b16 v[152:153], v70 offset:128
    ds_read_b64_tr_b16 v[154:155], v70 offset:2688
    ds_read_b64_tr_b16 v[156:157], v70 offset:160
    ds_read_b64_tr_b16 v[158:159], v70 offset:2720
    ds_read_b64_tr_b16 v[160:161], v70 offset:192
    ds_read_b64_tr_b16 v[162:163], v70 offset:2752
    ds_read_b64_tr_b16 v[164:165], v70 offset:224
    ds_read_b64_tr_b16 v[166:167], v70 offset:2784
    ds_read_b64_tr_b16 v[168:169], v70 offset:256
    ds_read_b64_tr_b16 v[170:171], v70 offset:2816
    ds_read_b64_tr_b16 v[172:173], v70 offset:288
    ds_read_b64_tr_b16 v[174:175], v70 offset:2848
    s_waitcnt lgkmcnt(15)
    buffer_store_dwordx4 v[136:139], v1, s[44:47], s86 offen offset:0 sc1
    buffer_store_dwordx4 v[140:143], v1, s[44:47], s86 offen offset:1024 sc1
    s_waitcnt lgkmcnt(14)
    buffer_store_dwordx4 v[144:147], v1, s[44:47], s86 offen offset:2048 sc1
    s_waitcnt lgkmcnt(12)
    buffer_store_dwordx4 v[148:151], v1, s[44:47], s86 offen offset:3072 sc1
    s_waitcnt lgkmcnt(10)
    s_add_u32 s86, s86, 4096
    buffer_store_dwordx4 v[152:155], v1, s[44:47], s86 offen offset:0 sc1
    s_add_u32 s86, s86, 272384
    s_waitcnt lgkmcnt(8)
    buffer_store_dwordx4 v[156:159], v1, s[44:47], s86 offen offset:0 sc1
    s_waitcnt lgkmcnt(6)
    buffer_store_dwordx4 v[160:163], v1, s[44:47], s86 offen offset:1024 sc1
    s_waitcnt lgkmcnt(4)
    buffer_store_dwordx4 v[164:167], v1, s[44:47], s86 offen offset:2048 sc1
    s_waitcnt lgkmcnt(2)
    buffer_store_dwordx4 v[168:171], v1, s[44:47], s86 offen offset:3072 sc1
    s_waitcnt lgkmcnt(0)
    s_add_u32 s86, s86, 4096
    buffer_store_dwordx4 v[172:175], v1, s[44:47], s86 offen offset:0 sc1
    s_waitcnt vmcnt(10)
    s_mov_b64 exec, 1
    buffer_store_dword v15, off, s[44:47], s90 sc1
    s_mov_b64 exec, -1
    s_waitcnt vmcnt(1)
    s_mov_b64 exec, 1
    buffer_store_dword v15, off, s[44:47], s91 sc1
    s_mov_b64 exec, -1
    s_branch G1_P
G1_NP:
    s_waitcnt vmcnt(0)
    s_mov_b64 exec, 1
    buffer_store_dword v15, off, s[44:47], s90 sc1
    s_mov_b64 exec, -1
G1_P:
    s_lshl_b32 s86, s49, 10
    s_add_u32 m0, s86, 84992
    s_nop 0
    buffer_load_dwordx4 v64, s[64:67], s85 offen lds
    s_add_u32 m0, m0, 4096
    s_add_u32 s85, s85, 55296
    buffer_load_dwordx4 v64, s[64:67], s85 offen lds
    s_add_u32 m0, m0, 4096
    s_add_u32 s85, s85, 55296
    buffer_load_dwordx4 v64, s[64:67], s85 offen lds
    s_add_u32 m0, m0, 4096
    s_add_u32 s85, s85, 55296
    buffer_load_dwordx4 v64, s[64:67], s85 offen lds
    s_add_u32 m0, m0, 4096
    s_add_u32 s85, s85, 55296
    buffer_load_dwordx4 v64, s[64:67], s85 offen lds
    s_add_u32 m0, m0, 4096
    s_add_u32 s85, s85, 55296
    buffer_load_dwordx4 v64, s[64:67], s85 offen lds
    s_add_u32 m0, m0, 4096
    s_add_u32 s85, s85, 55296
    buffer_load_dwordx4 v64, s[64:67], s85 offen lds
    s_add_u32 m0, m0, 4096
    s_add_u32 s85, s85, 55296
    buffer_load_dwordx4 v64, s[64:67], s85 offen lds
    s_add_u32 m0, m0, 4096
    s_add_u32 s85, s85, 55296
    buffer_load_dwordx4 v64, s[64:67], s85 offen lds
    s_add_u32 m0, m0, 4096
    s_add_u32 s85, s85, 55296
    buffer_load_dwordx4 v64, s[64:67], s85 offen lds
    s_add_u32 m0, m0, 4096
    s_add_u32 s85, s85, 55296
    buffer_load_dwordx4 v64, s[64:67], s85 offen lds
    s_add_u32 m0, m0, 4096
    s_add_u32 s85, s85, 55296
    buffer_load_dwordx4 v64, s[64:67], s85 offen lds
    s_add_u32 m0, m0, 4096
    s_add_u32 s85, s85, 55296
    buffer_load_dwordx4 v64, s[64:67], s85 offen lds
    s_add_u32 m0, m0, 4096
    s_add_u32 s85, s85, 55296
    buffer_load_dwordx4 v64, s[64:67], s85 offen lds
    s_add_u32 m0, m0, 4096
    s_add_u32 s85, s85, 55296
    buffer_load_dwordx4 v64, s[64:67], s85 offen lds
    s_add_u32 m0, m0, 4096
    s_add_u32 s85, s85, 55296
    buffer_load_dwordx4 v64, s[64:67], s85 offen lds
    s_add_u32 m0, m0, 4096
    s_add_u32 s85, s85, 55296
    s_mul_i32 s86, s49, 14
    v_add_u32 v70, s86, v0
    s_add_u32 s87, s86, 13
    s_min_u32 s87, s87, 53
    v_min_u32 v70, s87, v70
    v_lshlrev_b32 v70, 9, v70
    s_lshr_b32 s89, s53, 1
    s_lshl_b32 s89, s89, 7
    s_add_u32 s89, s89, 593920
    s_mul_i32 s84, s53, 54
    s_add_u32 s84, s84, s86
    s_mul_i32 s84, s84, 5120
    s_add_u32 s84, s84, 38797312
    s_mov_b32 s69, 65536
POLL_7:
    buffer_load_dword v14, v70, s[44:47], s89 offen sc1
    s_waitcnt vmcnt(0)
    v_cmp_ne_u32 vcc, s48, v14
    s_cbranch_vccz PDONE_8
    s_sub_u32 s69, s69, 1
    s_cbranch_scc0 POLL_7
PDONE_8:
    s_barrier
    ds_read_b64_tr_b16 v[84:85], v65 offset:12288
    ds_read_b64_tr_b16 v[86:87], v65 offset:12800
    ds_read_b64_tr_b16 v[88:89], v65 offset:16384
    ds_read_b64_tr_b16 v[90:91], v65 offset:16896
    ds_read_b64_tr_b16 v[92:93], v65 offset:20480
    ds_read_b64_tr_b16 v[94:95], v65 offset:20992
    ds_read_b64_tr_b16 v[96:97], v65 offset:24576
    ds_read_b64_tr_b16 v[98:99], v65 offset:25088
    ds_read_b64_tr_b16 v[100:101], v65 offset:28672
    ds_read_b64_tr_b16 v[102:103], v65 offset:29184
    ds_read_b64_tr_b16 v[104:105], v65 offset:32768
    ds_read_b64_tr_b16 v[106:107], v65 offset:33280
    ds_read_b64_tr_b16 v[108:109], v65 offset:36864
    ds_read_b64_tr_b16 v[110:111], v65 offset:37376
    ds_read_b64_tr_b16 v[112:113], v65 offset:40960
    ds_read_b64_tr_b16 v[114:115], v65 offset:41472
    ds_read_b64_tr_b16 v[116:117], v65 offset:45056
    ds_read_b64_tr_b16 v[118:119], v65 offset:45568
    ds_read_b64_tr_b16 v[120:121], v65 offset:49152
    ds_read_b64_tr_b16 v[122:123], v65 offset:49664
    ds_read_b64_tr_b16 v[124:125], v65 offset:53248
    ds_read_b64_tr_b16 v[126:127], v65 offset:53760
    ds_read_b64_tr_b16 v[128:129], v65 offset:57344
    ds_read_b64_tr_b16 v[130:131], v65 offset:57856
    ds_read_b64_tr_b16 v[132:133], v65 offset:61440
    ds_read_b64_tr_b16 v[134:135], v65 offset:61952
    ds_read_b64_tr_b16 v[72:73], v65 offset:0
    ds_read_b64_tr_b16 v[74:75], v65 offset:512
    ds_read_b64_tr_b16 v[76:77], v65 offset:4096
    ds_read_b64_tr_b16 v[78:79], v65 offset:4608
    ds_read_b64_tr_b16 v[80:81], v65 offset:8192
    ds_read_b64_tr_b16 v[82:83], v65 offset:8704
    s_waitcnt lgkmcnt(0)
    s_barrier
    s_lshl_b32 s86, s49, 10
    s_add_u32 m0, s86, 84992
    s_nop 0
    buffer_load_dwordx4 v64, s[64:67], s85 offen lds
    s_add_u32 m0, m0, 4096
    s_add_u32 s85, s85, 55296
    buffer_load_dwordx4 v64, s[64:67], s85 offen lds
    s_add_u32 m0, m0, 4096
    s_add_u32 s85, s85, 55296
    buffer_load_dwordx4 v64, s[64:67], s85 offen lds
    s_add_u32 m0, m0, 4096
    s_add_u32 s85, s85, 55296
    buffer_load_dwordx4 v64, s[64:67], s85 offen lds
    s_add_u32 m0, m0, 4096
    s_add_u32 s85, s85, 55296
    buffer_load_dwordx4 v64, s[64:67], s85 offen lds
    s_add_u32 m0, m0, 4096
    s_add_u32 s85, s85, 55296
    buffer_load_dwordx4 v64, s[64:67], s85 offen lds
    s_add_u32 m0, m0, 4096
    s_add_u32 s85, s85, 55296
    buffer_load_dwordx4 v64, s[64:67], s85 offen lds
    s_add_u32 m0, m0, 4096
    s_add_u32 s85, s85, 55296
    buffer_load_dwordx4 v64, s[64:67], s85 offen lds
    s_add_u32 m0, m0, 4096
    s_add_u32 s85, s85, 55296
    buffer_load_dwordx4 v64, s[64:67], s85 offen lds
    s_add_u32 m0, m0, 4096
    s_add_u32 s85, s85, 55296
    buffer_load_dwordx4 v64, s[64:67], s85 offen lds
    s_add_u32 m0, m0, 4096
    s_add_u32 s85, s85, 55296
    buffer_load_dwordx4 v64, s[64:67], s85 offen lds
    s_add_u32 m0, m0, 4096
    s_add_u32 s85, s85, 55296
    buffer_load_dwordx4 v64, s[64:67], s85 offen lds
    s_add_u32 m0, m0, 4096
    s_add_u32 s85, s85, 55296
    buffer_load_dwordx4 v64, s[64:67], s85 offen lds
    s_add_u32 m0, m0, 4096
    s_add_u32 s85, s85, 55296
    buffer_load_dwordx4 v64, s[64:67], s85 offen lds
    s_add_u32 m0, m0, 4096
    s_add_u32 s85, s85, 55296
    buffer_load_dwordx4 v64, s[64:67], s85 offen lds
    s_add_u32 m0, m0, 4096
    s_add_u32 s85, s85, 55296
    buffer_load_dwordx4 v64, s[64:67], s85 offen lds
    s_add_u32 m0, m0, 4096
    s_add_u32 s85, s85, 55296
    buffer_load_dwordx4 v[232:235], v1, s[44:47], s84 offen offset:0 sc1
    buffer_load_dwordx4 v[236:239], v1, s[44:47], s84 offen offset:1024 sc1
    buffer_load_dwordx4 v[240:243], v1, s[44:47], s84 offen offset:2048 sc1
    buffer_load_dwordx4 v[244:247], v1, s[44:47], s84 offen offset:3072 sc1
    s_add_u32 s84, s84, 4096
    buffer_load_dwordx4 v[248:251], v1, s[44:47], s84 offen offset:0 sc1
    buffer_load_dwordx4 v[252:255], v1, s[44:47], s84 offen offset:1024 sc1
    buffer_load_dwordx4 a[0:3], v1, s[44:47], s84 offen offset:2048 sc1
    buffer_load_dwordx4 a[32:35], v1, s[44:47], s84 offen offset:3072 sc1
    s_add_u32 s84, s84, 4096
    buffer_load_dwordx4 a[64:67], v1, s[44:47], s84 offen offset:0 sc1
    buffer_load_dwordx4 a[96:99], v1, s[44:47], s84 offen offset:1024 sc1
    buffer_load_dwordx4 a[156:159], v1, s[44:47], s84 offen offset:2048 sc1
    buffer_load_dwordx4 a[188:191], v1, s[44:47], s84 offen offset:3072 sc1
    s_add_u32 s84, s84, 4096
    buffer_load_dwordx4 a[220:223], v1, s[44:47], s84 offen offset:0 sc1
    buffer_load_dwordx4 a[252:255], v1, s[44:47], s84 offen offset:1024 sc1
    buffer_load_dwordx4 a[4:7], v1, s[44:47], s84 offen offset:2048 sc1
    buffer_load_dwordx4 a[36:39], v1, s[44:47], s84 offen offset:3072 sc1
    s_add_u32 s84, s84, 4096
    buffer_load_dwordx4 a[68:71], v1, s[44:47], s84 offen offset:0 sc1
    buffer_load_dwordx4 a[100:103], v1, s[44:47], s84 offen offset:1024 sc1
    buffer_load_dwordx4 a[152:155], v1, s[44:47], s84 offen offset:2048 sc1
    s_waitcnt vmcnt(19)
    s_barrier
    ds_read_b64_tr_b16 v[148:149], v65 offset:12288
    ds_read_b64_tr_b16 v[150:151], v65 offset:12800
    ds_read_b64_tr_b16 v[152:153], v65 offset:16384
    ds_read_b64_tr_b16 v[154:155], v65 offset:16896
    ds_read_b64_tr_b16 v[156:157], v65 offset:20480
    ds_read_b64_tr_b16 v[158:159], v65 offset:20992
    ds_read_b64_tr_b16 v[160:161], v65 offset:24576
    ds_read_b64_tr_b16 v[162:163], v65 offset:25088
    ds_read_b64_tr_b16 v[164:165], v65 offset:28672
    ds_read_b64_tr_b16 v[166:167], v65 offset:29184
    ds_read_b64_tr_b16 v[168:169], v65 offset:32768
    ds_read_b64_tr_b16 v[170:171], v65 offset:33280
    ds_read_b64_tr_b16 v[172:173], v65 offset:36864
    ds_read_b64_tr_b16 v[174:175], v65 offset:37376
    ds_read_b64_tr_b16 v[176:177], v65 offset:40960
    ds_read_b64_tr_b16 v[178:179], v65 offset:41472
    ds_read_b64_tr_b16 v[180:181], v65 offset:45056
    ds_read_b64_tr_b16 v[182:183], v65 offset:45568
    ds_read_b64_tr_b16 v[184:185], v65 offset:49152
    ds_read_b64_tr_b16 v[186:187], v65 offset:49664
    ds_read_b64_tr_b16 v[188:189], v65 offset:53248
    ds_read_b64_tr_b16 v[190:191], v65 offset:53760
    ds_read_b64_tr_b16 v[192:193], v65 offset:57344
    ds_read_b64_tr_b16 v[194:195], v65 offset:57856
    ds_read_b64_tr_b16 v[196:197], v65 offset:61440
    ds_read_b64_tr_b16 v[198:199], v65 offset:61952
    ds_read_b64_tr_b16 v[136:137], v65 offset:0
    ds_read_b64_tr_b16 v[138:139], v65 offset:512
    ds_read_b64_tr_b16 v[140:141], v65 offset:4096
    ds_read_b64_tr_b16 v[142:143], v65 offset:4608
    ds_read_b64_tr_b16 v[144:145], v65 offset:8192
    ds_read_b64_tr_b16 v[146:147], v65 offset:8704
    s_waitcnt lgkmcnt(0)
    s_barrier
    s_lshl_b32 s86, s49, 10
    s_add_u32 m0, s86, 84992
    s_nop 0
    buffer_load_dwordx4 v64, s[64:67], s85 offen lds
    s_add_u32 m0, m0, 4096
    s_add_u32 s85, s85, 55296
    buffer_load_dwordx4 v64, s[64:67], s85 offen lds
    s_add_u32 m0, m0, 4096
    s_add_u32 s85, s85, 55296
    buffer_load_dwordx4 v64, s[64:67], s85 offen lds
    s_add_u32 m0, m0, 4096
    s_add_u32 s85, s85, 55296
    buffer_load_dwordx4 v64, s[64:67], s85 offen lds
    s_add_u32 m0, m0, 4096
    s_add_u32 s85, s85, 55296
    buffer_load_dwordx4 v64, s[64:67], s85 offen lds
    s_add_u32 m0, m0, 4096
    s_add_u32 s85, s85, 55296
    buffer_load_dwordx4 v64, s[64:67], s85 offen lds
    s_add_u32 m0, m0, 4096
    s_add_u32 s85, s85, 55296
    buffer_load_dwordx4 v64, s[64:67], s85 offen lds
    s_add_u32 m0, m0, 4096
    s_add_u32 s85, s85, 55296
    buffer_load_dwordx4 v64, s[64:67], s85 offen lds
    s_add_u32 m0, m0, 4096
    s_add_u32 s85, s85, 55296
    buffer_load_dwordx4 a[184:187], v1, s[44:47], s84 offen offset:3072 sc1
    s_add_u32 s84, s84, 4096
    buffer_load_dwordx4 a[216:219], v1, s[44:47], s84 offen offset:0 sc1
    buffer_load_dwordx4 a[248:251], v1, s[44:47], s84 offen offset:1024 sc1
    buffer_load_dwordx4 a[8:11], v1, s[44:47], s84 offen offset:2048 sc1
    buffer_load_dwordx4 a[40:43], v1, s[44:47], s84 offen offset:3072 sc1
    s_add_u32 s84, s84, 4096
    buffer_load_dwordx4 a[72:75], v1, s[44:47], s84 offen offset:0 sc1
    buffer_load_dwordx4 a[104:107], v1, s[44:47], s84 offen offset:1024 sc1
    buffer_load_dwordx4 a[148:151], v1, s[44:47], s84 offen offset:2048 sc1
    buffer_load_dwordx4 a[180:183], v1, s[44:47], s84 offen offset:3072 sc1
    s_add_u32 s84, s84, 4096
    buffer_load_dwordx4 a[212:215], v1, s[44:47], s84 offen offset:0 sc1
    buffer_load_dwordx4 a[244:247], v1, s[44:47], s84 offen offset:1024 sc1
    buffer_load_dwordx4 a[12:15], v1, s[44:47], s84 offen offset:2048 sc1
    buffer_load_dwordx4 a[44:47], v1, s[44:47], s84 offen offset:3072 sc1
    s_add_u32 s84, s84, 4096
    buffer_load_dwordx4 a[76:79], v1, s[44:47], s84 offen offset:0 sc1
    buffer_load_dwordx4 a[108:111], v1, s[44:47], s84 offen offset:1024 sc1
    buffer_load_dwordx4 a[144:147], v1, s[44:47], s84 offen offset:2048 sc1
    buffer_load_dwordx4 a[176:179], v1, s[44:47], s84 offen offset:3072 sc1
    s_add_u32 s84, s84, 4096
    buffer_load_dwordx4 a[208:211], v1, s[44:47], s84 offen offset:0 sc1
    buffer_load_dwordx4 a[240:243], v1, s[44:47], s84 offen offset:1024 sc1
    s_waitcnt vmcnt(19)
    s_barrier
    ds_read_b64_tr_b16 v[212:213], v65 offset:12288
    ds_read_b64_tr_b16 v[214:215], v65 offset:12800
    ds_read_b64_tr_b16 v[216:217], v65 offset:16384
    ds_read_b64_tr_b16 v[218:219], v65 offset:16896
    ds_read_b64_tr_b16 v[220:221], v65 offset:20480
    ds_read_b64_tr_b16 v[222:223], v65 offset:20992
    ds_read_b64_tr_b16 v[224:225], v65 offset:24576
    ds_read_b64_tr_b16 v[226:227], v65 offset:25088
    ds_read_b64_tr_b16 v[228:229], v65 offset:28672
    ds_read_b64_tr_b16 v[230:231], v65 offset:29184
    ds_read_b64_tr_b16 v[200:201], v65 offset:0
    ds_read_b64_tr_b16 v[202:203], v65 offset:512
    ds_read_b64_tr_b16 v[204:205], v65 offset:4096
    ds_read_b64_tr_b16 v[206:207], v65 offset:4608
    ds_read_b64_tr_b16 v[208:209], v65 offset:8192
    ds_read_b64_tr_b16 v[210:211], v65 offset:8704
    s_waitcnt lgkmcnt(0)
    s_barrier
    s_mov_b32 s77, 462848
    s_mul_i32 s79, s54, 81920
    s_add_u32 s79, s79, s82
    s_add_u32 s79, s79, 9437184
    s_add_u32 s70, s79, 40960
    s_lshl_b32 s81, s2, 2
    s_add_u32 s81, s81, s49
    s_lshl_b32 s81, s81, 7
    s_add_u32 s81, s81, 1544192
    s_mov_b32 s62, 0
    s_branch G1_LATE
R_CONV:
    s_waitcnt vmcnt(3)
    s_barrier
    ds_read_b64_tr_b16 v[84:85], v65 offset:12288
    ds_read_b64_tr_b16 v[86:87], v65 offset:12800
    ds_read_b64_tr_b16 v[88:89], v65 offset:16384
    ds_read_b64_tr_b16 v[90:91], v65 offset:16896
    ds_read_b64_tr_b16 v[92:93], v65 offset:20480
    ds_read_b64_tr_b16 v[94:95], v65 offset:20992
    ds_read_b64_tr_b16 v[96:97], v65 offset:24576
    ds_read_b64_tr_b16 v[98:99], v65 offset:25088
    ds_read_b64_tr_b16 v[100:101], v65 offset:28672
    ds_read_b64_tr_b16 v[102:103], v65 offset:29184
    ds_read_b64_tr_b16 v[104:105], v65 offset:32768
    ds_read_b64_tr_b16 v[106:107], v65 offset:33280
    ds_read_b64_tr_b16 v[108:109], v65 offset:36864
    ds_read_b64_tr_b16 v[110:111], v65 offset:37376
    ds_read_b64_tr_b16 v[112:113], v65 offset:40960
    ds_read_b64_tr_b16 v[114:115], v65 offset:41472
    ds_read_b64_tr_b16 v[116:117], v65 offset:45056
    ds_read_b64_tr_b16 v[118:119], v65 offset:45568
    ds_read_b64_tr_b16 v[120:121], v65 offset:49152
    ds_read_b64_tr_b16 v[122:123], v65 offset:49664
    ds_read_b64_tr_b16 v[124:125], v65 offset:53248
    ds_read_b64_tr_b16 v[126:127], v65 offset:53760
    ds_read_b64_tr_b16 v[128:129], v65 offset:57344
    ds_read_b64_tr_b16 v[130:131], v65 offset:57856
    ds_read_b64_tr_b16 v[132:133], v65 offset:61440
    ds_read_b64_tr_b16 v[134:135], v65 offset:61952
    ds_read_b64_tr_b16 v[72:73], v65 offset:0
    ds_read_b64_tr_b16 v[74:75], v65 offset:512
    ds_read_b64_tr_b16 v[76:77], v65 offset:4096
    ds_read_b64_tr_b16 v[78:79], v65 offset:4608
    ds_read_b64_tr_b16 v[80:81], v65 offset:8192
    ds_read_b64_tr_b16 v[82:83], v65 offset:8704
    s_waitcnt lgkmcnt(0)
    s_barrier
    s_waitcnt vmcnt(0)
    s_mov_b64 exec, 1
    buffer_store_dword v15, off, s[44:47], s90 sc1
    s_mov_b64 exec, -1
    s_mul_i32 s86, s49, 21248
    s_add_u32 s87, s86, 4080
    v_sub_u32 v38, s87, v1
    v_subrev_u32 v38, 3072, v38
    s_mov_b32 s88, 0xffff
    v_mov_b32 v16, 0
    v_mov_b32 v17, 0
    v_mov_b32 v18, 0
    v_mov_b32 v19, 0
    v_lshrrev_b32 v39, 1, v1
    s_add_u32 s87, s86, 16640
    v_add_u32 v39, s87, v39
    ds_write_b64 v39, v[16:17]
    v_bfe_u32 v39, v0, 1, 2
    v_mul_u32_u24 v39, 4160, v39
    v_and_b32 v36, 1, v0
    v_lshl_add_u32 v39, v36, 4, v39
    s_add_u32 s87, s86, 4096
    v_add_u32 v39, s87, v39
    ds_write_b128 v39, v[16:19]
    s_lshl_b32 s86, s49, 10
    s_add_u32 m0, s86, 84992
    v_alignbit_b32 v16, v45, v45, 16
    v_alignbit_b32 v17, v44, v44, 16
    v_alignbit_b32 v18, v43, v43, 16
    v_alignbit_b32 v19, v42, v42, 16
    ds_write_b128 v38, v[16:19] offset:3072
    buffer_load_dwordx4 v64, s[64:67], s85 offen lds
    s_add_u32 m0, m0, 4096
    s_add_u32 s85, s85, 55296
    v_bfi_b32 v20, s88, v45, v44
    v_bfi_b32 v21, s88, v44, v43
    v_bfi_b32 v22, s88, v43, v42
    v_bfi_b32 v23, s88, v42, v41
    ds_write_b128 v38, v[20:23] offset:7232
    buffer_load_dwordx4 v64, s[64:67], s85 offen lds
    s_add_u32 m0, m0, 4096
    s_add_u32 s85, s85, 55296
    v_alignbit_b32 v24, v44, v44, 16
    v_alignbit_b32 v25, v43, v43, 16
    v_alignbit_b32 v26, v42, v42, 16
    v_alignbit_b32 v27, v41, v41, 16
    ds_write_b128 v38, v[24:27] offset:11392
    buffer_load_dwordx4 v64, s[64:67], s85 offen lds
    s_add_u32 m0, m0, 4096
    s_add_u32 s85, s85, 55296
    v_bfi_b32 v28, s88, v44, v43
    v_bfi_b32 v29, s88, v43, v42
    v_bfi_b32 v30, s88, v42, v41
    v_bfi_b32 v31, s88, v41, v40
    ds_write_b128 v38, v[28:31] offset:15552
    buffer_load_dwordx4 v64, s[64:67], s85 offen lds
    s_add_u32 m0, m0, 4096
    s_add_u32 s85, s85, 55296
    v_alignbit_b32 v16, v51, v51, 16
    v_alignbit_b32 v17, v50, v50, 16
    v_alignbit_b32 v18, v49, v49, 16
    v_alignbit_b32 v19, v48, v48, 16
    ds_write_b128 v38, v[16:19] offset:2048
    buffer_load_dwordx4 v64, s[64:67], s85 offen lds
    s_add_u32 m0, m0, 4096
    s_add_u32 s85, s85, 55296
    v_bfi_b32 v20, s88, v51, v50
    v_bfi_b32 v21, s88, v50, v49
    v_bfi_b32 v22, s88, v49, v48
    v_bfi_b32 v23, s88, v48, v47
    ds_write_b128 v38, v[20:23] offset:6208
    buffer_load_dwordx4 v64, s[64:67], s85 offen lds
    s_add_u32 m0, m0, 4096
    s_add_u32 s85, s85, 55296
    v_alignbit_b32 v24, v50, v50, 16
    v_alignbit_b32 v25, v49, v49, 16
    v_alignbit_b32 v26, v48, v48, 16
    v_alignbit_b32 v27, v47, v47, 16
    ds_write_b128 v38, v[24:27] offset:10368
    buffer_load_dwordx4 v64, s[64:67], s85 offen lds
    s_add_u32 m0, m0, 4096
    s_add_u32 s85, s85, 55296
    v_bfi_b32 v28, s88, v50, v49
    v_bfi_b32 v29, s88, v49, v48
    v_bfi_b32 v30, s88, v48, v47
    v_bfi_b32 v31, s88, v47, v46
    ds_write_b128 v38, v[28:31] offset:14528
    buffer_load_dwordx4 v64, s[64:67], s85 offen lds
    s_add_u32 m0, m0, 4096
    s_add_u32 s85, s85, 55296
    v_alignbit_b32 v16, v57, v57, 16
    v_alignbit_b32 v17, v56, v56, 16
    v_alignbit_b32 v18, v55, v55, 16
    v_alignbit_b32 v19, v54, v54, 16
    ds_write_b128 v38, v[16:19] offset:1024
    buffer_load_dwordx4 v64, s[64:67], s85 offen lds
    s_add_u32 m0, m0, 4096
    s_add_u32 s85, s85, 55296
    v_bfi_b32 v20, s88, v57, v56
    v_bfi_b32 v21, s88, v56, v55
    v_bfi_b32 v22, s88, v55, v54
    v_bfi_b32 v23, s88, v54, v53
    ds_write_b128 v38, v[20:23] offset:5184
    buffer_load_dwordx4 v64, s[64:67], s85 offen lds
    s_add_u32 m0, m0, 4096
    s_add_u32 s85, s85, 55296
    v_alignbit_b32 v24, v56, v56, 16
    v_alignbit_b32 v25, v55, v55, 16
    v_alignbit_b32 v26, v54, v54, 16
    v_alignbit_b32 v27, v53, v53, 16
    ds_write_b128 v38, v[24:27] offset:9344
    buffer_load_dwordx4 v64, s[64:67], s85 offen lds
    s_add_u32 m0, m0, 4096
    s_add_u32 s85, s85, 55296
    v_bfi_b32 v28, s88, v56, v55
    v_bfi_b32 v29, s88, v55, v54
    v_bfi_b32 v30, s88, v54, v53
    v_bfi_b32 v31, s88, v53, v52
    ds_write_b128 v38, v[28:31] offset:13504
    buffer_load_dwordx4 v64, s[64:67], s85 offen lds
    s_add_u32 m0, m0, 4096
    s_add_u32 s85, s85, 55296
    v_alignbit_b32 v16, v63, v63, 16
    v_alignbit_b32 v17, v62, v62, 16
    v_alignbit_b32 v18, v61, v61, 16
    v_alignbit_b32 v19, v60, v60, 16
    ds_write_b128 v38, v[16:19] offset:0
    buffer_load_dwordx4 v64, s[64:67], s85 offen lds
    s_add_u32 m0, m0, 4096
    s_add_u32 s85, s85, 55296
    v_bfi_b32 v20, s88, v63, v62
    v_bfi_b32 v21, s88, v62, v61
    v_bfi_b32 v22, s88, v61, v60
    v_bfi_b32 v23, s88, v60, v59
    ds_write_b128 v38, v[20:23] offset:4160
    buffer_load_dwordx4 v64, s[64:67], s85 offen lds
    s_add_u32 m0, m0, 4096
    s_add_u32 s85, s85, 55296
    v_alignbit_b32 v24, v62, v62, 16
    v_alignbit_b32 v25, v61, v61, 16
    v_alignbit_b32 v26, v60, v60, 16
    v_alignbit_b32 v27, v59, v59, 16
    ds_write_b128 v38, v[24:27] offset:8320
    buffer_load_dwordx4 v64, s[64:67], s85 offen lds
    s_add_u32 m0, m0, 4096
    s_add_u32 s85, s85, 55296
    v_bfi_b32 v28, s88, v62, v61
    v_bfi_b32 v29, s88, v61, v60
    v_bfi_b32 v30, s88, v60, v59
    v_bfi_b32 v31, s88, v59, v58
    ds_write_b128 v38, v[28:31] offset:12480
    buffer_load_dwordx4 v64, s[64:67], s85 offen lds
    s_add_u32 m0, m0, 4096
    s_add_u32 s85, s85, 55296
    v_and_b32 v16, 15, v0
    v_lshrrev_b32 v17, 4, v0
    v_lshrrev_b32 v18, 3, v16
    v_add_u32 v18, 2, v18
    v_cmp_eq_u32 vcc, v17, v18
    v_and_b32 v19, 1, v0
    v_lshlrev_b32 v19, 4, v19
    v_lshlrev_b32 v37, v19, v37
    v_cndmask_b32 v37, 0, v37, vcc
    v_bfe_u32 v19, v0, 1, 2
    s_mul_i32 s86, s49, 21248
    v_cmp_eq_u32 vcc, 0, v19
    s_nop 1
    v_cndmask_b32 v32, 0, v37, vcc
    v_cmp_eq_u32 vcc, 1, v19
    s_nop 1
    v_cndmask_b32 v33, 0, v37, vcc
    v_cmp_eq_u32 vcc, 2, v19
    s_nop 1
    v_cndmask_b32 v34, 0, v37, vcc
    v_cmp_eq_u32 vcc, 3, v19
    s_nop 1
    v_cndmask_b32 v35, 0, v37, vcc
    v_sub_u32 v18, 3, v16
    v_and_b32 v18, 3, v18
    v_mul_u32_u24 v18, 4160, v18
    v_lshl_add_u32 v18, v17, 4, v18
    v_lshrrev_b32 v19, 2, v16
    v_lshlrev_b32 v19, 3, v19
    v_sub_u32 v18, v18, v19
    s_add_u32 s87, s86, 24
    v_add_u32 v36, s87, v18
    v_lshlrev_b32 v18, 5, v16
    v_lshl_add_u32 v18, v17, 4, v18
    s_add_u32 s87, s86, 16672
    v_add_u32 v39, s87, v18
    s_lshl_b32 s87, s49, 2
    v_add_u32 v18, s87, v17
    v_xor_b32 v18, v18, v16
    v_lshlrev_b32 v18, 3, v18
    v_lshl_add_u32 v18, v16, 7, v18
    v_add_u32 v66, 153600, v18
    v_bfe_u32 v18, v0, 1, 1
    v_lshl_add_u32 v18, v17, 1, v18
    s_lshl_b32 s87, s49, 3
    v_add_u32 v18, s87, v18
    v_bfe_u32 v19, v0, 2, 2
    v_and_b32 v20, 1, v0
    v_lshl_add_u32 v19, v19, 2, v20
    v_and_b32 v20, 15, v18
    v_xor_b32 v19, v19, v20
    v_lshlrev_b32 v19, 3, v19
    v_lshl_add_u32 v19, v18, 7, v19
    v_add_u32 v67, 153600, v19
    v_xor_b32 v69, 16, v67
    v_lshrrev_b32 v18, 3, v0
    v_mul_u32_u24 v18, 20480, v18
    v_and_b32 v19, 7, v0
    v_lshl_add_u32 v68, v19, 4, v18
    v_and_b32 v37, 31, v0
    v_lshlrev_b32 v37, 7, v37
    s_mul_i32 s86, s51, 52
    s_lshr_b32 s86, s86, 8
    s_lshl_b32 s87, s50, 2
    s_add_u32 s86, s86, s87
    s_lshl_b32 s86, s86, 12
    s_add_u32 s90, s86, 4096
    buffer_load_dword v14, v37, s[44:47], s90 offen sc1
    ds_read_b64 a[0:1], v36 offset:4032
    ds_read_b64 a[2:3], v36 offset:4040
    ds_read_b64 a[4:5], v36 offset:3968
    ds_read_b64 a[6:7], v36 offset:3976
    ds_read_b64 a[8:9], v36 offset:3904
    ds_read_b64 a[10:11], v36 offset:3912
    ds_read_b64 a[12:13], v36 offset:3840
    ds_read_b64 a[14:15], v36 offset:3848
    ds_read_b64 a[16:17], v36 offset:3776
    ds_read_b64 a[18:19], v36 offset:3784
    ds_read_b64 a[20:21], v36 offset:3712
    ds_read_b64 a[22:23], v36 offset:3720
    ds_read_b64 a[24:25], v36 offset:3648
    ds_read_b64 a[26:27], v36 offset:3656
    ds_read_b64 a[28:29], v36 offset:3584
    ds_read_b64 a[30:31], v36 offset:3592
    ds_read_b64 a[32:33], v36 offset:3520
    ds_read_b64 a[34:35], v36 offset:3528
    ds_read_b64 a[36:37], v36 offset:3456
    ds_read_b64 a[38:39], v36 offset:3464
    ds_read_b64 a[40:41], v36 offset:3392
    ds_read_b64 a[42:43], v36 offset:3400
    ds_read_b64 a[44:45], v36 offset:3328
    ds_read_b64 a[46:47], v36 offset:3336
    ds_read_b64 a[48:49], v36 offset:3264
    ds_read_b64 a[50:51], v36 offset:3272
    ds_read_b64 a[52:53], v36 offset:3200
    ds_read_b64 a[54:55], v36 offset:3208
    ds_read_b64 a[56:57], v36 offset:3136
    ds_read_b64 a[58:59], v36 offset:3144
    ds_read_b64 a[60:61], v36 offset:3072
    ds_read_b64 a[62:63], v36 offset:3080
    ds_read_b64 a[64:65], v36 offset:3008
    ds_read_b64 a[66:67], v36 offset:3016
    ds_read_b64 a[68:69], v36 offset:2944
    ds_read_b64 a[70:71], v36 offset:2952
    ds_read_b64 a[72:73], v36 offset:2880
    ds_read_b64 a[74:75], v36 offset:2888
    ds_read_b64 a[76:77], v36 offset:2816
    ds_read_b64 a[78:79], v36 offset:2824
    ds_read_b64 a[80:81], v36 offset:2752
    ds_read_b64 a[82:83], v36 offset:2760
    ds_read_b64 a[84:85], v36 offset:2688
    ds_read_b64 a[86:87], v36 offset:2696
    ds_read_b64 a[88:89], v36 offset:2624
    ds_read_b64 a[90:91], v36 offset:2632
    ds_read_b64 a[92:93], v36 offset:2560
    ds_read_b64 a[94:95], v36 offset:2568
    ds_read_b64 a[96:97], v36 offset:2496
    ds_read_b64 a[98:99], v36 offset:2504
    ds_read_b64 a[100:101], v36 offset:2432
    ds_read_b64 a[102:103], v36 offset:2440
    ds_read_b64 a[104:105], v36 offset:2368
    ds_read_b64 a[106:107], v36 offset:2376
    ds_read_b64 a[108:109], v36 offset:2304
    ds_read_b64 a[110:111], v36 offset:2312
    ds_read_b64 a[112:113], v36 offset:2240
    ds_read_b64 a[114:115], v36 offset:2248
    ds_read_b64 a[116:117], v36 offset:2176
    ds_read_b64 a[118:119], v36 offset:2184
    ds_read_b64 a[120:121], v36 offset:2112
    ds_read_b64 a[122:123], v36 offset:2120
    ds_read_b64 a[124:125], v36 offset:2048
    ds_read_b64 a[126:127], v36 offset:2056
    s_mul_i32 s86, s49, 14
    v_add_u32 v70, s86, v0
    s_add_u32 s87, s86, 13
    s_min_u32 s87, s87, 53
    v_min_u32 v70, s87, v70
    v_lshlrev_b32 v70, 9, v70
    s_lshr_b32 s89, s53, 1
    s_lshl_b32 s89, s89, 7
    s_add_u32 s89, s89, 593920
    s_mul_i32 s84, s53, 54
    s_add_u32 s84, s84, s86
    s_mul_i32 s84, s84, 5120
    s_add_u32 s84, s84, 38797312
    s_mov_b32 s77, 462848
    s_mul_i32 s79, s54, 81920
    s_add_u32 s79, s79, s82
    s_add_u32 s79, s79, 9437184
    s_add_u32 s70, s79, 40960
    s_mul_i32 s87, s50, 20
    s_add_u32 s87, s87, s51
    s_lshl_b32 s88, s87, 2
    s_add_u32 s88, s88, s49
    s_lshl_b32 s88, s88, 12
    s_add_u32 s88, s88, 3145728
    s_mul_i32 s86, s49, 21248
    s_add_u32 m0, s86, 17152
    s_mul_i32 s86, s49, 1280
    s_add_u32 s86, s86, s87
    s_lshl_b32 s86, s86, 7
    s_add_u32 s80, s86, 6291456
    s_mul_i32 s86, s49, 160
    s_add_u32 s86, s86, s87
    s_lshl_b32 s86, s86, 7
    s_add_u32 s81, s86, 135168
    s_waitcnt vmcnt(0)
    v_cmp_ne_u32 vcc, s48, v14
    s_cbranch_vccnz SPIN_9
SRET_10:
    buffer_load_dwordx4 v1, s[44:47], s88 offen offset:0 sc1 lds
    buffer_load_dwordx4 v1, s[44:47], s88 offen offset:1024 sc1 lds
    buffer_load_dwordx4 v1, s[44:47], s88 offen offset:2048 sc1 lds
    buffer_load_dwordx4 v1, s[44:47], s88 offen offset:3072 sc1 lds
    s_barrier
    ds_read_b64_tr_b16 v[136:137], v65 offset:0
    ds_read_b64_tr_b16 v[138:139], v65 offset:512
    ds_read_b64_tr_b16 v[140:141], v65 offset:4096
    ds_read_b64_tr_b16 v[142:143], v65 offset:4608
    ds_read_b64_tr_b16 v[144:145], v65 offset:8192
    ds_read_b64_tr_b16 v[146:147], v65 offset:8704
    ds_read_b64_tr_b16 v[148:149], v65 offset:12288
    ds_read_b64_tr_b16 v[150:151], v65 offset:12800
    ds_read_b64_tr_b16 v[152:153], v65 offset:16384
    ds_read_b64_tr_b16 v[154:155], v65 offset:16896
    ds_read_b64_tr_b16 v[156:157], v65 offset:20480
    ds_read_b64_tr_b16 v[158:159], v65 offset:20992
    ds_read_b64_tr_b16 v[160:161], v65 offset:24576
    ds_read_b64_tr_b16 v[162:163], v65 offset:25088
    ds_read_b64_tr_b16 v[164:165], v65 offset:28672
    ds_read_b64_tr_b16 v[166:167], v65 offset:29184
    ds_read_b64_tr_b16 v[168:169], v65 offset:32768
    ds_read_b64_tr_b16 v[170:171], v65 offset:33280
    ds_read_b64_tr_b16 v[172:173], v65 offset:36864
    ds_read_b64_tr_b16 v[174:175], v65 offset:37376
    ds_read_b64_tr_b16 v[176:177], v65 offset:40960
    ds_read_b64_tr_b16 v[178:179], v65 offset:41472
    ds_read_b64_tr_b16 v[180:181], v65 offset:45056
    ds_read_b64_tr_b16 v[182:183], v65 offset:45568
    ds_read_b64_tr_b16 v[184:185], v65 offset:49152
    ds_read_b64_tr_b16 v[186:187], v65 offset:49664
    ds_read_b64_tr_b16 v[188:189], v65 offset:53248
    ds_read_b64_tr_b16 v[190:191], v65 offset:53760
    ds_read_b64_tr_b16 v[192:193], v65 offset:57344
    ds_read_b64_tr_b16 v[194:195], v65 offset:57856
    ds_read_b64_tr_b16 v[196:197], v65 offset:61440
    ds_read_b64_tr_b16 v[198:199], v65 offset:61952
    s_waitcnt vmcnt(0) lgkmcnt(0)
    ds_read_b128 a[156:159], v39 offset:448
    ds_read_b128 a[188:191], v39 offset:960
    ds_read_b128 a[152:155], v39 offset:384
    ds_read_b128 a[184:187], v39 offset:896
    s_waitcnt lgkmcnt(3)
    v_mfma_f32_16x16x32_bf16 v[16:19], v[32:35], a[156:159], 0
    ds_read_b128 a[148:151], v39 offset:320
    s_waitcnt lgkmcnt(3)
    v_mfma_f32_16x16x32_bf16 v[20:23], v[32:35], a[188:191], 0
    ds_read_b128 a[180:183], v39 offset:832
    v_mfma_f32_16x16x32_bf16 v[16:19], a[0:3], a[156:159], v[16:19]
    ds_read_b128 a[144:147], v39 offset:256
    v_mfma_f32_16x16x32_bf16 v[20:23], a[0:3], a[188:191], v[20:23]
    ds_read_b128 a[176:179], v39 offset:768
    v_mfma_f32_16x16x32_bf16 v[20:23], a[32:35], a[156:159], v[20:23]
    ds_read_b128 a[140:143], v39 offset:192
    s_waitcnt lgkmcnt(6)
    v_mfma_f32_16x16x32_bf16 v[16:19], a[4:7], a[152:155], v[16:19]
    ds_read_b128 a[172:175], v39 offset:704
    s_waitcnt lgkmcnt(6)
    v_mfma_f32_16x16x32_bf16 v[20:23], a[4:7], a[184:187], v[20:23]
    ds_read_b128 a[136:139], v39 offset:128
    v_mfma_f32_16x16x32_bf16 v[20:23], a[36:39], a[152:155], v[20:23]
    ds_read_b128 a[168:171], v39 offset:640
    s_waitcnt lgkmcnt(7)
    v_mfma_f32_16x16x32_bf16 v[16:19], a[8:11], a[148:151], v[16:19]
    ds_read_b128 a[132:135], v39 offset:64
    s_waitcnt lgkmcnt(7)
    v_mfma_f32_16x16x32_bf16 v[20:23], a[8:11], a[180:183], v[20:23]
    ds_read_b128 a[164:167], v39 offset:576
    v_mfma_f32_16x16x32_bf16 v[20:23], a[40:43], a[148:151], v[20:23]
    ds_read_b128 a[128:131], v39 offset:0
    s_waitcnt lgkmcnt(8)
    v_mfma_f32_16x16x32_bf16 v[16:19], a[12:15], a[144:147], v[16:19]
    ds_read_b128 a[160:163], v39 offset:512
    s_waitcnt lgkmcnt(8)
    v_mfma_f32_16x16x32_bf16 v[20:23], a[12:15], a[176:179], v[20:23]
    ds_read_b128 a[220:223], v39 offset:1472
    v_mfma_f32_16x16x32_bf16 v[20:23], a[44:47], a[144:147], v[20:23]
    ds_read_b128 a[252:255], v39 offset:1984
    s_waitcnt lgkmcnt(9)
    v_mfma_f32_16x16x32_bf16 v[16:19], a[16:19], a[140:143], v[16:19]
    ds_read_b128 a[216:219], v39 offset:1408
    s_waitcnt lgkmcnt(9)
    v_mfma_f32_16x16x32_bf16 v[20:23], a[16:19], a[172:175], v[20:23]
    ds_read_b128 a[248:251], v39 offset:1920
    v_mfma_f32_16x16x32_bf16 v[20:23], a[48:51], a[140:143], v[20:23]
    ds_read_b128 a[212:215], v39 offset:1344
    s_waitcnt lgkmcnt(10)
    v_mfma_f32_16x16x32_bf16 v[16:19], a[20:23], a[136:139], v[16:19]
    ds_read_b128 a[244:247], v39 offset:1856
    s_waitcnt lgkmcnt(10)
    v_mfma_f32_16x16x32_bf16 v[20:23], a[20:23], a[168:171], v[20:23]
    ds_read_b128 a[208:211], v39 offset:1280
    v_mfma_f32_16x16x32_bf16 v[20:23], a[52:55], a[136:139], v[20:23]
    ds_read_b128 a[240:243], v39 offset:1792
    s_waitcnt lgkmcnt(11)
    v_mfma_f32_16x16x32_bf16 v[16:19], a[24:27], a[132:135], v[16:19]
    ds_read_b128 a[204:207], v39 offset:1216
    s_waitcnt lgkmcnt(11)
    v_mfma_f32_16x16x32_bf16 v[20:23], a[24:27], a[164:167], v[20:23]
    ds_read_b128 a[236:239], v39 offset:1728
    v_mfma_f32_16x16x32_bf16 v[20:23], a[56:59], a[132:135], v[20:23]
    ds_read_b128 a[200:203], v39 offset:1152
    s_waitcnt lgkmcnt(12)
    v_mfma_f32_16x16x32_bf16 v[16:19], a[28:31], a[128:131], v[16:19]
    ds_read_b128 a[232:235], v39 offset:1664
    s_waitcnt lgkmcnt(12)
    v_mfma_f32_16x16x32_bf16 v[20:23], a[28:31], a[160:163], v[20:23]
    ds_read_b128 a[196:199], v39 offset:1088
    v_mfma_f32_16x16x32_bf16 v[20:23], a[60:63], a[128:131], v[20:23]
    ds_read_b128 a[228:231], v39 offset:1600
    ds_read_b128 a[192:195], v39 offset:1024
    ds_read_b128 a[224:227], v39 offset:1536
    s_waitcnt lgkmcnt(15)
    v_mfma_f32_16x16x32_bf16 v[24:27], v[32:35], a[220:223], 0
    s_waitcnt lgkmcnt(14)
    v_mfma_f32_16x16x32_bf16 v[28:31], v[32:35], a[252:255], 0
    v_mfma_f32_16x16x32_bf16 v[24:27], a[0:3], a[220:223], v[24:27]
    v_cvt_pk_bf16_f32 v56, v16, v17
    v_cvt_pk_bf16_f32 v57, v18, v19
    v_mfma_f32_16x16x32_bf16 v[24:27], a[32:35], a[188:191], v[24:27]
    ds_write_b64 v66, v[56:57] offset:0
    v_mfma_f32_16x16x32_bf16 v[24:27], a[64:67], a[156:159], v[24:27]
    v_cvt_pk_bf16_f32 v58, v20, v21
    v_cvt_pk_bf16_f32 v59, v22, v23
    v_mfma_f32_16x16x32_bf16 v[28:31], a[0:3], a[252:255], v[28:31]
    ds_write_b64 v66, v[58:59] offset:2048
    v_mfma_f32_16x16x32_bf16 v[28:31], a[32:35], a[220:223], v[28:31]
    v_mfma_f32_16x16x32_bf16 v[28:31], a[64:67], a[188:191], v[28:31]
    v_mfma_f32_16x16x32_bf16 v[28:31], a[96:99], a[156:159], v[28:31]
    s_waitcnt lgkmcnt(0)
    s_barrier
    v_mfma_f32_16x16x32_bf16 v[24:27], a[4:7], a[216:219], v[24:27]
    ds_read_b64_tr_b16 v[60:61], v67 offset:0
    v_mfma_f32_16x16x32_bf16 v[24:27], a[36:39], a[184:187], v[24:27]
    ds_read_b64_tr_b16 v[62:63], v69 offset:0
    v_mfma_f32_16x16x32_bf16 v[24:27], a[68:71], a[152:155], v[24:27]
    v_mfma_f32_16x16x32_bf16 v[28:31], a[4:7], a[248:251], v[28:31]
    v_mfma_f32_16x16x32_bf16 v[28:31], a[36:39], a[216:219], v[28:31]
    v_mfma_f32_16x16x32_bf16 v[28:31], a[68:71], a[184:187], v[28:31]
    v_mfma_f32_16x16x32_bf16 v[28:31], a[100:103], a[152:155], v[28:31]
    s_waitcnt lgkmcnt(0)
    buffer_store_dwordx4 v[60:63], v68, s[44:47], s80 offen sc1
    s_add_u32 s80, s80, 655360
    v_mfma_f32_16x16x32_bf16 v[24:27], a[8:11], a[212:215], v[24:27]
    buffer_load_dword v14, v70, s[44:47], s89 offen sc1
    v_mfma_f32_16x16x32_bf16 v[24:27], a[40:43], a[180:183], v[24:27]
    ds_read_b128 v[216:219], v39 offset:2496
    v_mfma_f32_16x16x32_bf16 v[24:27], a[72:75], a[148:151], v[24:27]
    s_lshl_b32 s86, s49, 10
    s_add_u32 m0, s86, 84992
    v_mfma_f32_16x16x32_bf16 v[28:31], a[8:11], a[244:247], v[28:31]
    ds_read_b64 v[200:201], v36 offset:1984
    v_mfma_f32_16x16x32_bf16 v[28:31], a[40:43], a[212:215], v[28:31]
    buffer_load_dwordx4 v64, s[64:67], s85 offen lds
    s_add_u32 m0, m0, 4096
    s_add_u32 s85, s85, 55296
    v_mfma_f32_16x16x32_bf16 v[28:31], a[72:75], a[180:183], v[28:31]
    ds_read_b64 v[202:203], v36 offset:1992
    v_mfma_f32_16x16x32_bf16 v[28:31], a[104:107], a[148:151], v[28:31]
    buffer_load_dwordx4 v64, s[64:67], s85 offen lds
    s_add_u32 m0, m0, 4096
    s_add_u32 s85, s85, 55296
    v_mfma_f32_16x16x32_bf16 v[24:27], a[12:15], a[208:211], v[24:27]
    ds_read_b128 v[220:223], v39 offset:3008
    v_mfma_f32_16x16x32_bf16 v[24:27], a[44:47], a[176:179], v[24:27]
    buffer_load_dwordx4 v64, s[64:67], s85 offen lds
    s_add_u32 m0, m0, 4096
    s_add_u32 s85, s85, 55296
    v_mfma_f32_16x16x32_bf16 v[24:27], a[76:79], a[144:147], v[24:27]
    ds_read_b64 v[204:205], v36 offset:1472
    v_mfma_f32_16x16x32_bf16 v[28:31], a[12:15], a[240:243], v[28:31]
    buffer_load_dwordx4 v64, s[64:67], s85 offen lds
    s_add_u32 m0, m0, 4096
    s_add_u32 s85, s85, 55296
    v_mfma_f32_16x16x32_bf16 v[28:31], a[44:47], a[208:211], v[28:31]
    ds_read_b64 v[206:207], v36 offset:1480
    v_mfma_f32_16x16x32_bf16 v[28:31], a[76:79], a[176:179], v[28:31]
    buffer_load_dwordx4 v64, s[64:67], s85 offen lds
    s_add_u32 m0, m0, 4096
    s_add_u32 s85, s85, 55296
    v_mfma_f32_16x16x32_bf16 v[28:31], a[108:111], a[144:147], v[28:31]
    ds_read_b128 v[224:227], v39 offset:3520
    v_mfma_f32_16x16x32_bf16 v[24:27], a[16:19], a[204:207], v[24:27]
    buffer_load_dwordx4 v64, s[64:67], s85 offen lds
    s_add_u32 m0, m0, 4096
    s_add_u32 s85, s85, 55296
    v_mfma_f32_16x16x32_bf16 v[24:27], a[48:51], a[172:175], v[24:27]
    ds_read_b64 v[208:209], v36 offset:960
    v_mfma_f32_16x16x32_bf16 v[24:27], a[80:83], a[140:143], v[24:27]
    buffer_load_dwordx4 v64, s[64:67], s85 offen lds
    s_add_u32 m0, m0, 4096
    s_add_u32 s85, s85, 55296
    v_mfma_f32_16x16x32_bf16 v[28:31], a[16:19], a[236:239], v[28:31]
    ds_read_b64 v[210:211], v36 offset:968
    v_mfma_f32_16x16x32_bf16 v[28:31], a[48:51], a[204:207], v[28:31]
    buffer_load_dwordx4 v64, s[64:67], s85 offen lds
    s_add_u32 m0, m0, 4096
    s_add_u32 s85, s85, 55296
    v_mfma_f32_16x16x32_bf16 v[28:31], a[80:83], a[172:175], v[28:31]
    ds_read_b128 v[228:231], v39 offset:4032
    v_mfma_f32_16x16x32_bf16 v[28:31], a[112:115], a[140:143], v[28:31]
    ds_read_b64 v[212:213], v36 offset:448
    v_mfma_f32_16x16x32_bf16 v[24:27], a[20:23], a[200:203], v[24:27]
    ds_read_b64 v[214:215], v36 offset:456
    v_mfma_f32_16x16x32_bf16 v[24:27], a[52:55], a[168:171], v[24:27]
    v_mfma_f32_16x16x32_bf16 v[24:27], a[84:87], a[136:139], v[24:27]
    v_mfma_f32_16x16x32_bf16 v[28:31], a[20:23], a[232:235], v[28:31]
    v_mfma_f32_16x16x32_bf16 v[28:31], a[52:55], a[200:203], v[28:31]
    v_mfma_f32_16x16x32_bf16 v[28:31], a[84:87], a[168:171], v[28:31]
    v_mfma_f32_16x16x32_bf16 v[28:31], a[116:119], a[136:139], v[28:31]
    v_mfma_f32_16x16x32_bf16 v[24:27], a[24:27], a[196:199], v[24:27]
    v_mfma_f32_16x16x32_bf16 v[24:27], a[56:59], a[164:167], v[24:27]
    v_mfma_f32_16x16x32_bf16 v[24:27], a[88:91], a[132:135], v[24:27]
    v_mfma_f32_16x16x32_bf16 v[28:31], a[24:27], a[228:231], v[28:31]
    v_mfma_f32_16x16x32_bf16 v[28:31], a[56:59], a[196:199], v[28:31]
    v_mfma_f32_16x16x32_bf16 v[28:31], a[88:91], a[164:167], v[28:31]
    v_mfma_f32_16x16x32_bf16 v[28:31], a[120:123], a[132:135], v[28:31]
    v_mfma_f32_16x16x32_bf16 v[24:27], a[28:31], a[192:195], v[24:27]
    v_mfma_f32_16x16x32_bf16 v[24:27], a[60:63], a[160:163], v[24:27]
    v_mfma_f32_16x16x32_bf16 v[24:27], a[92:95], a[128:131], v[24:27]
    v_mfma_f32_16x16x32_bf16 v[28:31], a[28:31], a[224:227], v[28:31]
    v_mfma_f32_16x16x32_bf16 v[28:31], a[60:63], a[192:195], v[28:31]
    v_mfma_f32_16x16x32_bf16 v[28:31], a[92:95], a[160:163], v[28:31]
    v_mfma_f32_16x16x32_bf16 v[28:31], a[124:127], a[128:131], v[28:31]
    s_waitcnt vmcnt(9)
    s_mov_b64 exec, 1
    buffer_store_dword v15, off, s[44:47], s81 sc1
    s_mov_b64 exec, -1
    s_add_u32 s81, s81, 81920
    s_waitcnt lgkmcnt(11)
    v_mfma_f32_16x16x32_bf16 v[16:19], v[32:35], v[216:219], 0
    s_waitcnt lgkmcnt(8)
    v_mfma_f32_16x16x32_bf16 v[20:23], v[32:35], v[220:223], 0
    s_waitcnt lgkmcnt(5)
    v_mfma_f32_16x16x32_bf16 v[48:51], v[32:35], v[224:227], 0
    v_cvt_pk_bf16_f32 v56, v24, v25
    v_cvt_pk_bf16_f32 v57, v26, v27
    s_waitcnt lgkmcnt(2)
    v_mfma_f32_16x16x32_bf16 v[52:55], v[32:35], v[228:231], 0
    ds_write_b64 v66, v[56:57] offset:4096
    v_mfma_f32_16x16x32_bf16 v[16:19], a[64:67], a[220:223], v[16:19]
    v_cvt_pk_bf16_f32 v58, v28, v29
    v_cvt_pk_bf16_f32 v59, v30, v31
    v_mfma_f32_16x16x32_bf16 v[16:19], a[32:35], a[252:255], v[16:19]
    ds_write_b64 v66, v[58:59] offset:6144
    v_mfma_f32_16x16x32_bf16 v[20:23], a[64:67], a[252:255], v[20:23]
    v_mfma_f32_16x16x32_bf16 v[16:19], a[96:99], a[188:191], v[16:19]
    v_mfma_f32_16x16x32_bf16 v[20:23], a[96:99], a[220:223], v[20:23]
    s_waitcnt lgkmcnt(0)
    s_barrier
    v_mfma_f32_16x16x32_bf16 v[48:51], a[96:99], a[252:255], v[48:51]
    ds_read_b64_tr_b16 v[60:61], v67 offset:4096
    v_mfma_f32_16x16x32_bf16 v[16:19], a[0:3], v[216:219], v[16:19]
    ds_read_b64_tr_b16 v[62:63], v69 offset:4096
    v_mfma_f32_16x16x32_bf16 v[20:23], a[32:35], v[216:219], v[20:23]
    v_mfma_f32_16x16x32_bf16 v[48:51], a[64:67], v[216:219], v[48:51]
    v_mfma_f32_16x16x32_bf16 v[52:55], a[96:99], v[216:219], v[52:55]
    s_waitcnt lgkmcnt(0)
    buffer_store_dwordx4 v[60:63], v68, s[44:47], s80 offen sc1
    s_add_u32 s80, s80, 655360
    v_mfma_f32_16x16x32_bf16 v[16:19], v[200:203], a[156:159], v[16:19]
    ds_read_b128 v[248:251], v39 offset:2432
    v_mfma_f32_16x16x32_bf16 v[20:23], v[200:203], a[188:191], v[20:23]
    ds_read_b64 v[232:233], v36 offset:1920
    v_mfma_f32_16x16x32_bf16 v[48:51], v[200:203], a[220:223], v[48:51]
    ds_read_b64 v[234:235], v36 offset:1928
    v_mfma_f32_16x16x32_bf16 v[52:55], v[200:203], a[252:255], v[52:55]
    ds_read_b128 v[252:255], v39 offset:2944
    v_mfma_f32_16x16x32_bf16 v[20:23], a[0:3], v[220:223], v[20:23]
    ds_read_b64 v[236:237], v36 offset:1408
    v_mfma_f32_16x16x32_bf16 v[48:51], a[32:35], v[220:223], v[48:51]
    ds_read_b64 v[238:239], v36 offset:1416
    v_mfma_f32_16x16x32_bf16 v[52:55], a[64:67], v[220:223], v[52:55]
    ds_read_b128 v[40:43], v39 offset:3456
    v_mfma_f32_16x16x32_bf16 v[20:23], v[204:207], a[156:159], v[20:23]
    ds_read_b64 v[240:241], v36 offset:896
    v_mfma_f32_16x16x32_bf16 v[48:51], v[204:207], a[188:191], v[48:51]
    ds_read_b64 v[242:243], v36 offset:904
    v_mfma_f32_16x16x32_bf16 v[52:55], v[204:207], a[220:223], v[52:55]
    ds_read_b128 v[44:47], v39 offset:3968
    v_mfma_f32_16x16x32_bf16 v[48:51], a[0:3], v[224:227], v[48:51]
    ds_read_b64 v[244:245], v36 offset:384
    v_mfma_f32_16x16x32_bf16 v[52:55], a[32:35], v[224:227], v[52:55]
    ds_read_b64 v[246:247], v36 offset:392
    v_mfma_f32_16x16x32_bf16 v[48:51], v[208:211], a[156:159], v[48:51]
    v_mfma_f32_16x16x32_bf16 v[52:55], v[208:211], a[188:191], v[52:55]
    v_mfma_f32_16x16x32_bf16 v[52:55], a[0:3], v[228:231], v[52:55]
    v_mfma_f32_16x16x32_bf16 v[52:55], v[212:215], a[156:159], v[52:55]
    v_mfma_f32_16x16x32_bf16 v[16:19], a[68:71], a[216:219], v[16:19]
    ds_read_b128 a[156:159], v39 offset:2368
    v_mfma_f32_16x16x32_bf16 v[16:19], a[36:39], a[248:251], v[16:19]
    ds_read_b64 a[0:1], v36 offset:1856
    v_mfma_f32_16x16x32_bf16 v[20:23], a[68:71], a[248:251], v[20:23]
    ds_read_b64 a[2:3], v36 offset:1864
    v_mfma_f32_16x16x32_bf16 v[16:19], a[100:103], a[184:187], v[16:19]
    ds_read_b128 a[188:191], v39 offset:2880
    v_mfma_f32_16x16x32_bf16 v[20:23], a[100:103], a[216:219], v[20:23]
    ds_read_b64 a[32:33], v36 offset:1344
    v_mfma_f32_16x16x32_bf16 v[48:51], a[100:103], a[248:251], v[48:51]
    ds_read_b64 a[34:35], v36 offset:1352
    s_waitcnt lgkmcnt(15)
    v_mfma_f32_16x16x32_bf16 v[16:19], a[4:7], v[248:251], v[16:19]
    ds_read_b128 a[220:223], v39 offset:3392
    v_mfma_f32_16x16x32_bf16 v[20:23], a[36:39], v[248:251], v[20:23]
    ds_read_b64 a[64:65], v36 offset:832
    v_mfma_f32_16x16x32_bf16 v[48:51], a[68:71], v[248:251], v[48:51]
    ds_read_b64 a[66:67], v36 offset:840
    v_mfma_f32_16x16x32_bf16 v[52:55], a[100:103], v[248:251], v[52:55]
    ds_read_b128 a[252:255], v39 offset:3904
    v_mfma_f32_16x16x32_bf16 v[16:19], v[232:235], a[152:155], v[16:19]
    ds_read_b64 a[96:97], v36 offset:320
    v_mfma_f32_16x16x32_bf16 v[20:23], v[232:235], a[184:187], v[20:23]
    ds_read_b64 a[98:99], v36 offset:328
    v_mfma_f32_16x16x32_bf16 v[48:51], v[232:235], a[216:219], v[48:51]
    v_mfma_f32_16x16x32_bf16 v[52:55], v[232:235], a[248:251], v[52:55]
    s_waitcnt lgkmcnt(15)
    v_mfma_f32_16x16x32_bf16 v[20:23], a[4:7], v[252:255], v[20:23]
    v_mfma_f32_16x16x32_bf16 v[48:51], a[36:39], v[252:255], v[48:51]
    v_mfma_f32_16x16x32_bf16 v[52:55], a[68:71], v[252:255], v[52:55]
    v_mfma_f32_16x16x32_bf16 v[20:23], v[236:239], a[152:155], v[20:23]
    v_mfma_f32_16x16x32_bf16 v[48:51], v[236:239], a[184:187], v[48:51]
    v_mfma_f32_16x16x32_bf16 v[52:55], v[236:239], a[216:219], v[52:55]
    v_mfma_f32_16x16x32_bf16 v[48:51], a[4:7], v[40:43], v[48:51]
    v_mfma_f32_16x16x32_bf16 v[52:55], a[36:39], v[40:43], v[52:55]
    v_mfma_f32_16x16x32_bf16 v[48:51], v[240:243], a[152:155], v[48:51]
    v_mfma_f32_16x16x32_bf16 v[52:55], v[240:243], a[184:187], v[52:55]
    s_waitcnt lgkmcnt(14)
    v_mfma_f32_16x16x32_bf16 v[52:55], a[4:7], v[44:47], v[52:55]
    s_waitcnt lgkmcnt(12)
    v_mfma_f32_16x16x32_bf16 v[52:55], v[244:247], a[152:155], v[52:55]
    v_mfma_f32_16x16x32_bf16 v[16:19], a[72:75], a[212:215], v[16:19]
    s_waitcnt vmcnt(10)
    v_cmp_ne_u32 vcc, s48, v14
    s_cbranch_vccnz SPIN_11
SRET_12:
    v_mfma_f32_16x16x32_bf16 v[16:19], a[40:43], a[244:247], v[16:19]
    s_waitcnt vmcnt(0)
    s_mov_b64 exec, 1
    buffer_store_dword v15, off, s[44:47], s81 sc1
    s_mov_b64 exec, -1
    s_add_u32 s81, s81, 81920
    v_mfma_f32_16x16x32_bf16 v[20:23], a[72:75], a[244:247], v[20:23]
    ds_read_b128 a[152:155], v39 offset:2304
    v_mfma_f32_16x16x32_bf16 v[16:19], a[104:107], a[180:183], v[16:19]
    buffer_load_dwordx4 v[232:235], v1, s[44:47], s84 offen offset:0 sc1
    v_mfma_f32_16x16x32_bf16 v[20:23], a[104:107], a[212:215], v[20:23]
    ds_read_b64 a[4:5], v36 offset:1792
    v_mfma_f32_16x16x32_bf16 v[48:51], a[104:107], a[244:247], v[48:51]
    buffer_load_dwordx4 v[236:239], v1, s[44:47], s84 offen offset:1024 sc1
    s_waitcnt lgkmcnt(13)
    v_mfma_f32_16x16x32_bf16 v[16:19], a[8:11], a[156:159], v[16:19]
    ds_read_b64 a[6:7], v36 offset:1800
    v_mfma_f32_16x16x32_bf16 v[20:23], a[40:43], a[156:159], v[20:23]
    buffer_load_dwordx4 v[240:243], v1, s[44:47], s84 offen offset:2048 sc1
    v_mfma_f32_16x16x32_bf16 v[48:51], a[72:75], a[156:159], v[48:51]
    ds_read_b128 a[184:187], v39 offset:2816
    v_mfma_f32_16x16x32_bf16 v[52:55], a[104:107], a[156:159], v[52:55]
    buffer_load_dwordx4 v[244:247], v1, s[44:47], s84 offen offset:3072 sc1
    s_add_u32 s84, s84, 4096
    s_waitcnt lgkmcnt(13)
    v_mfma_f32_16x16x32_bf16 v[16:19], a[0:3], a[148:151], v[16:19]
    ds_read_b64 a[36:37], v36 offset:1280
    v_mfma_f32_16x16x32_bf16 v[20:23], a[0:3], a[180:183], v[20:23]
    buffer_load_dwordx4 v[248:251], v1, s[44:47], s84 offen offset:0 sc1
    v_mfma_f32_16x16x32_bf16 v[48:51], a[0:3], a[212:215], v[48:51]
    ds_read_b64 a[38:39], v36 offset:1288
    v_mfma_f32_16x16x32_bf16 v[52:55], a[0:3], a[244:247], v[52:55]
    buffer_load_dwordx4 v[252:255], v1, s[44:47], s84 offen offset:1024 sc1
    s_waitcnt lgkmcnt(14)
    v_mfma_f32_16x16x32_bf16 v[20:23], a[8:11], a[188:191], v[20:23]
    ds_read_b128 a[216:219], v39 offset:3328
    v_mfma_f32_16x16x32_bf16 v[48:51], a[40:43], a[188:191], v[48:51]
    ds_read_b64 a[68:69], v36 offset:768
    v_mfma_f32_16x16x32_bf16 v[52:55], a[72:75], a[188:191], v[52:55]
    ds_read_b64 a[70:71], v36 offset:776
    s_waitcnt lgkmcnt(15)
    v_mfma_f32_16x16x32_bf16 v[20:23], a[32:35], a[148:151], v[20:23]
    ds_read_b128 a[248:251], v39 offset:3840
    v_mfma_f32_16x16x32_bf16 v[48:51], a[32:35], a[180:183], v[48:51]
    ds_read_b64 a[100:101], v36 offset:256
    v_mfma_f32_16x16x32_bf16 v[52:55], a[32:35], a[212:215], v[52:55]
    ds_read_b64 a[102:103], v36 offset:264
    s_waitcnt lgkmcnt(15)
    v_mfma_f32_16x16x32_bf16 v[48:51], a[8:11], a[220:223], v[48:51]
    v_mfma_f32_16x16x32_bf16 v[52:55], a[40:43], a[220:223], v[52:55]
    v_mfma_f32_16x16x32_bf16 v[48:51], a[64:67], a[148:151], v[48:51]
    v_mfma_f32_16x16x32_bf16 v[52:55], a[64:67], a[180:183], v[52:55]
    s_waitcnt lgkmcnt(14)
    v_mfma_f32_16x16x32_bf16 v[52:55], a[8:11], a[252:255], v[52:55]
    s_waitcnt lgkmcnt(12)
    v_mfma_f32_16x16x32_bf16 v[52:55], a[96:99], a[148:151], v[52:55]
    v_mfma_f32_16x16x32_bf16 v[16:19], a[76:79], a[208:211], v[16:19]
    ds_read_b128 a[148:151], v39 offset:2240
    v_mfma_f32_16x16x32_bf16 v[16:19], a[44:47], a[240:243], v[16:19]
    buffer_load_dwordx4 a[0:3], v1, s[44:47], s84 offen offset:2048 sc1
    v_mfma_f32_16x16x32_bf16 v[20:23], a[76:79], a[240:243], v[20:23]
    ds_read_b64 a[8:9], v36 offset:1728
    v_mfma_f32_16x16x32_bf16 v[16:19], a[108:111], a[176:179], v[16:19]
    buffer_load_dwordx4 a[32:35], v1, s[44:47], s84 offen offset:3072 sc1
    s_add_u32 s84, s84, 4096
    v_mfma_f32_16x16x32_bf16 v[20:23], a[108:111], a[208:211], v[20:23]
    ds_read_b64 a[10:11], v36 offset:1736
    v_mfma_f32_16x16x32_bf16 v[48:51], a[108:111], a[240:243], v[48:51]
    buffer_load_dwordx4 a[64:67], v1, s[44:47], s84 offen offset:0 sc1
    s_waitcnt lgkmcnt(14)
    v_mfma_f32_16x16x32_bf16 v[16:19], a[12:15], a[152:155], v[16:19]
    ds_read_b128 a[180:183], v39 offset:2752
    v_mfma_f32_16x16x32_bf16 v[20:23], a[44:47], a[152:155], v[20:23]
    buffer_load_dwordx4 a[96:99], v1, s[44:47], s84 offen offset:1024 sc1
    v_mfma_f32_16x16x32_bf16 v[48:51], a[76:79], a[152:155], v[48:51]
    ds_read_b64 a[40:41], v36 offset:1216
    v_mfma_f32_16x16x32_bf16 v[52:55], a[108:111], a[152:155], v[52:55]
    buffer_load_dwordx4 a[156:159], v1, s[44:47], s84 offen offset:2048 sc1
    s_waitcnt lgkmcnt(14)
    v_mfma_f32_16x16x32_bf16 v[16:19], a[4:7], a[144:147], v[16:19]
    ds_read_b64 a[42:43], v36 offset:1224
    v_mfma_f32_16x16x32_bf16 v[20:23], a[4:7], a[176:179], v[20:23]
    buffer_load_dwordx4 a[188:191], v1, s[44:47], s84 offen offset:3072 sc1
    s_add_u32 s84, s84, 4096
    v_mfma_f32_16x16x32_bf16 v[48:51], a[4:7], a[208:211], v[48:51]
    ds_read_b128 a[212:215], v39 offset:3264
    v_mfma_f32_16x16x32_bf16 v[52:55], a[4:7], a[240:243], v[52:55]
    buffer_load_dwordx4 a[220:223], v1, s[44:47], s84 offen offset:0 sc1
    s_waitcnt lgkmcnt(15)
    v_mfma_f32_16x16x32_bf16 v[20:23], a[12:15], a[184:187], v[20:23]
    ds_read_b64 a[72:73], v36 offset:704
    v_mfma_f32_16x16x32_bf16 v[48:51], a[44:47], a[184:187], v[48:51]
    buffer_load_dwordx4 a[252:255], v1, s[44:47], s84 offen offset:1024 sc1
    v_mfma_f32_16x16x32_bf16 v[52:55], a[76:79], a[184:187], v[52:55]
    ds_read_b64 a[74:75], v36 offset:712
    s_waitcnt lgkmcnt(15)
    v_mfma_f32_16x16x32_bf16 v[20:23], a[36:39], a[144:147], v[20:23]
    ds_read_b128 a[244:247], v39 offset:3776
    v_mfma_f32_16x16x32_bf16 v[48:51], a[36:39], a[176:179], v[48:51]
    ds_read_b64 a[104:105], v36 offset:192
    v_mfma_f32_16x16x32_bf16 v[52:55], a[36:39], a[208:211], v[52:55]
    ds_read_b64 a[106:107], v36 offset:200
    s_waitcnt lgkmcnt(15)
    v_mfma_f32_16x16x32_bf16 v[48:51], a[12:15], a[216:219], v[48:51]
    v_mfma_f32_16x16x32_bf16 v[52:55], a[44:47], a[216:219], v[52:55]
    v_mfma_f32_16x16x32_bf16 v[48:51], a[68:71], a[144:147], v[48:51]
    v_mfma_f32_16x16x32_bf16 v[52:55], a[68:71], a[176:179], v[52:55]
    s_waitcnt lgkmcnt(14)
    v_mfma_f32_16x16x32_bf16 v[52:55], a[12:15], a[248:251], v[52:55]
    s_waitcnt lgkmcnt(12)
    v_mfma_f32_16x16x32_bf16 v[52:55], a[100:103], a[144:147], v[52:55]
    v_mfma_f32_16x16x32_bf16 v[16:19], a[80:83], a[204:207], v[16:19]
    ds_read_b128 a[144:147], v39 offset:2176
    v_mfma_f32_16x16x32_bf16 v[16:19], a[48:51], a[236:239], v[16:19]
    buffer_load_dwordx4 a[4:7], v1, s[44:47], s84 offen offset:2048 sc1
    v_mfma_f32_16x16x32_bf16 v[20:23], a[80:83], a[236:239], v[20:23]
    ds_read_b64 a[12:13], v36 offset:1664
    v_mfma_f32_16x16x32_bf16 v[16:19], a[112:115], a[172:175], v[16:19]
    buffer_load_dwordx4 a[36:39], v1, s[44:47], s84 offen offset:3072 sc1
    s_add_u32 s84, s84, 4096
    v_mfma_f32_16x16x32_bf16 v[20:23], a[112:115], a[204:207], v[20:23]
    ds_read_b64 a[14:15], v36 offset:1672
    v_mfma_f32_16x16x32_bf16 v[48:51], a[112:115], a[236:239], v[48:51]
    buffer_load_dwordx4 a[68:71], v1, s[44:47], s84 offen offset:0 sc1
    s_waitcnt lgkmcnt(14)
    v_mfma_f32_16x16x32_bf16 v[16:19], a[16:19], a[148:151], v[16:19]
    ds_read_b128 a[176:179], v39 offset:2688
    v_mfma_f32_16x16x32_bf16 v[20:23], a[48:51], a[148:151], v[20:23]
    buffer_load_dwordx4 a[100:103], v1, s[44:47], s84 offen offset:1024 sc1
    v_mfma_f32_16x16x32_bf16 v[48:51], a[80:83], a[148:151], v[48:51]
    ds_read_b64 a[44:45], v36 offset:1152
    v_mfma_f32_16x16x32_bf16 v[52:55], a[112:115], a[148:151], v[52:55]
    buffer_load_dwordx4 a[152:155], v1, s[44:47], s84 offen offset:2048 sc1
    s_waitcnt lgkmcnt(14)
    v_mfma_f32_16x16x32_bf16 v[16:19], a[8:11], a[140:143], v[16:19]
    ds_read_b64 a[46:47], v36 offset:1160
    v_mfma_f32_16x16x32_bf16 v[20:23], a[8:11], a[172:175], v[20:23]
    buffer_load_dwordx4 a[184:187], v1, s[44:47], s84 offen offset:3072 sc1
    s_add_u32 s84, s84, 4096
    v_mfma_f32_16x16x32_bf16 v[48:51], a[8:11], a[204:207], v[48:51]
    ds_read_b128 a[208:211], v39 offset:3200
    v_mfma_f32_16x16x32_bf16 v[52:55], a[8:11], a[236:239], v[52:55]
    buffer_load_dwordx4 a[216:219], v1, s[44:47], s84 offen offset:0 sc1
    s_waitcnt lgkmcnt(15)
    v_mfma_f32_16x16x32_bf16 v[20:23], a[16:19], a[180:183], v[20:23]
    ds_read_b64 a[76:77], v36 offset:640
    v_mfma_f32_16x16x32_bf16 v[48:51], a[48:51], a[180:183], v[48:51]
    buffer_load_dwordx4 a[248:251], v1, s[44:47], s84 offen offset:1024 sc1
    v_mfma_f32_16x16x32_bf16 v[52:55], a[80:83], a[180:183], v[52:55]
    ds_read_b64 a[78:79], v36 offset:648
    s_waitcnt lgkmcnt(15)
    v_mfma_f32_16x16x32_bf16 v[20:23], a[40:43], a[140:143], v[20:23]
    ds_read_b128 a[240:243], v39 offset:3712
    v_mfma_f32_16x16x32_bf16 v[48:51], a[40:43], a[172:175], v[48:51]
    ds_read_b64 a[108:109], v36 offset:128
    v_mfma_f32_16x16x32_bf16 v[52:55], a[40:43], a[204:207], v[52:55]
    ds_read_b64 a[110:111], v36 offset:136
    s_waitcnt lgkmcnt(15)
    v_mfma_f32_16x16x32_bf16 v[48:51], a[16:19], a[212:215], v[48:51]
    v_mfma_f32_16x16x32_bf16 v[52:55], a[48:51], a[212:215], v[52:55]
    v_mfma_f32_16x16x32_bf16 v[48:51], a[72:75], a[140:143], v[48:51]
    v_mfma_f32_16x16x32_bf16 v[52:55], a[72:75], a[172:175], v[52:55]
    s_waitcnt lgkmcnt(14)
    v_mfma_f32_16x16x32_bf16 v[52:55], a[16:19], a[244:247], v[52:55]
    s_waitcnt lgkmcnt(12)
    v_mfma_f32_16x16x32_bf16 v[52:55], a[104:107], a[140:143], v[52:55]
    v_mfma_f32_16x16x32_bf16 v[16:19], a[84:87], a[200:203], v[16:19]
    s_barrier
    v_mfma_f32_16x16x32_bf16 v[16:19], a[52:55], a[232:235], v[16:19]
    ds_read_b128 a[140:143], v39 offset:2112
    v_mfma_f32_16x16x32_bf16 v[20:23], a[84:87], a[232:235], v[20:23]
    buffer_load_dwordx4 a[8:11], v1, s[44:47], s84 offen offset:2048 sc1
    v_mfma_f32_16x16x32_bf16 v[16:19], a[116:119], a[168:171], v[16:19]
    ds_read_b64 a[16:17], v36 offset:1600
    v_mfma_f32_16x16x32_bf16 v[20:23], a[116:119], a[200:203], v[20:23]
    buffer_load_dwordx4 a[40:43], v1, s[44:47], s84 offen offset:3072 sc1
    s_add_u32 s84, s84, 4096
    v_mfma_f32_16x16x32_bf16 v[48:51], a[116:119], a[232:235], v[48:51]
    ds_read_b64 a[18:19], v36 offset:1608
    s_waitcnt lgkmcnt(14)
    v_mfma_f32_16x16x32_bf16 v[16:19], a[20:23], a[144:147], v[16:19]
    buffer_load_dwordx4 a[72:75], v1, s[44:47], s84 offen offset:0 sc1
    v_mfma_f32_16x16x32_bf16 v[20:23], a[52:55], a[144:147], v[20:23]
    ds_read_b128 a[172:175], v39 offset:2624
    v_mfma_f32_16x16x32_bf16 v[48:51], a[84:87], a[144:147], v[48:51]
    buffer_load_dwordx4 a[104:107], v1, s[44:47], s84 offen offset:1024 sc1
    v_mfma_f32_16x16x32_bf16 v[52:55], a[116:119], a[144:147], v[52:55]
    ds_read_b64 a[48:49], v36 offset:1088
    s_waitcnt lgkmcnt(14)
    v_mfma_f32_16x16x32_bf16 v[16:19], a[12:15], a[136:139], v[16:19]
    buffer_load_dwordx4 a[148:151], v1, s[44:47], s84 offen offset:2048 sc1
    v_mfma_f32_16x16x32_bf16 v[20:23], a[12:15], a[168:171], v[20:23]
    ds_read_b64 a[50:51], v36 offset:1096
    v_mfma_f32_16x16x32_bf16 v[48:51], a[12:15], a[200:203], v[48:51]
    buffer_load_dwordx4 a[180:183], v1, s[44:47], s84 offen offset:3072 sc1
    s_add_u32 s84, s84, 4096
    v_mfma_f32_16x16x32_bf16 v[52:55], a[12:15], a[232:235], v[52:55]
    ds_read_b128 a[204:207], v39 offset:3136
    s_waitcnt lgkmcnt(15)
    v_mfma_f32_16x16x32_bf16 v[20:23], a[20:23], a[176:179], v[20:23]
    buffer_load_dwordx4 a[212:215], v1, s[44:47], s84 offen offset:0 sc1
    v_mfma_f32_16x16x32_bf16 v[48:51], a[52:55], a[176:179], v[48:51]
    ds_read_b64 a[80:81], v36 offset:576
    v_mfma_f32_16x16x32_bf16 v[52:55], a[84:87], a[176:179], v[52:55]
    buffer_load_dwordx4 a[244:247], v1, s[44:47], s84 offen offset:1024 sc1
    s_waitcnt lgkmcnt(14)
    v_mfma_f32_16x16x32_bf16 v[20:23], a[44:47], a[136:139], v[20:23]
    ds_read_b64 a[82:83], v36 offset:584
    v_mfma_f32_16x16x32_bf16 v[48:51], a[44:47], a[168:171], v[48:51]
    ds_read_b128 a[236:239], v39 offset:3648
    v_mfma_f32_16x16x32_bf16 v[52:55], a[44:47], a[200:203], v[52:55]
    ds_read_b64 a[112:113], v36 offset:64
    s_waitcnt lgkmcnt(15)
    v_mfma_f32_16x16x32_bf16 v[48:51], a[20:23], a[208:211], v[48:51]
    ds_read_b64 a[114:115], v36 offset:72
    v_mfma_f32_16x16x32_bf16 v[52:55], a[52:55], a[208:211], v[52:55]
    ds_read_b64_tr_b16 v[200:201], v65 offset:0
    s_waitcnt lgkmcnt(15)
    v_mfma_f32_16x16x32_bf16 v[48:51], a[76:79], a[136:139], v[48:51]
    ds_read_b64_tr_b16 v[202:203], v65 offset:512
    v_mfma_f32_16x16x32_bf16 v[52:55], a[76:79], a[168:171], v[52:55]
    ds_read_b64_tr_b16 v[204:205], v65 offset:4096
    v_mfma_f32_16x16x32_bf16 v[52:55], a[20:23], a[240:243], v[52:55]
    ds_read_b64_tr_b16 v[206:207], v65 offset:4608
    s_waitcnt lgkmcnt(15)
    v_mfma_f32_16x16x32_bf16 v[52:55], a[108:111], a[136:139], v[52:55]
    ds_read_b64_tr_b16 v[208:209], v65 offset:8192
    ds_read_b64_tr_b16 v[210:211], v65 offset:8704
    ds_read_b64_tr_b16 v[212:213], v65 offset:12288
    ds_read_b64_tr_b16 v[214:215], v65 offset:12800
    v_mfma_f32_16x16x32_bf16 v[16:19], a[88:91], a[196:199], v[16:19]
    ds_read_b128 a[136:139], v39 offset:2048
    v_mfma_f32_16x16x32_bf16 v[16:19], a[56:59], a[228:231], v[16:19]
    buffer_load_dword v14, v10, s[44:47], s77 offen sc1
    v_mfma_f32_16x16x32_bf16 v[20:23], a[88:91], a[228:231], v[20:23]
    ds_read_b64 a[20:21], v36 offset:1536
    v_mfma_f32_16x16x32_bf16 v[16:19], a[120:123], a[164:167], v[16:19]
    buffer_load_dwordx4 a[12:15], v1, s[44:47], s84 offen offset:2048 sc1
    v_mfma_f32_16x16x32_bf16 v[20:23], a[120:123], a[196:199], v[20:23]
    ds_read_b64 a[22:23], v36 offset:1544
    v_mfma_f32_16x16x32_bf16 v[48:51], a[120:123], a[228:231], v[48:51]
    buffer_load_dwordx4 a[44:47], v1, s[44:47], s84 offen offset:3072 sc1
    s_add_u32 s84, s84, 4096
    v_mfma_f32_16x16x32_bf16 v[16:19], a[24:27], a[140:143], v[16:19]
    ds_read_b128 a[168:171], v39 offset:2560
    v_mfma_f32_16x16x32_bf16 v[20:23], a[56:59], a[140:143], v[20:23]
    buffer_load_dwordx4 a[76:79], v1, s[44:47], s84 offen offset:0 sc1
    v_mfma_f32_16x16x32_bf16 v[48:51], a[88:91], a[140:143], v[48:51]
    ds_read_b64 a[52:53], v36 offset:1024
    v_mfma_f32_16x16x32_bf16 v[52:55], a[120:123], a[140:143], v[52:55]
    buffer_load_dwordx4 a[108:111], v1, s[44:47], s84 offen offset:1024 sc1
    s_waitcnt lgkmcnt(15)
    v_mfma_f32_16x16x32_bf16 v[16:19], a[16:19], a[132:135], v[16:19]
    ds_read_b64 a[54:55], v36 offset:1032
    v_mfma_f32_16x16x32_bf16 v[20:23], a[16:19], a[164:167], v[20:23]
    buffer_load_dwordx4 a[144:147], v1, s[44:47], s84 offen offset:2048 sc1
    v_mfma_f32_16x16x32_bf16 v[48:51], a[16:19], a[196:199], v[48:51]
    ds_read_b128 a[200:203], v39 offset:3072
    v_mfma_f32_16x16x32_bf16 v[52:55], a[16:19], a[228:231], v[52:55]
    buffer_load_dwordx4 a[176:179], v1, s[44:47], s84 offen offset:3072 sc1
    s_add_u32 s84, s84, 4096
    v_mfma_f32_16x16x32_bf16 v[20:23], a[24:27], a[172:175], v[20:23]
    ds_read_b64 a[84:85], v36 offset:512
    v_mfma_f32_16x16x32_bf16 v[48:51], a[56:59], a[172:175], v[48:51]
    buffer_load_dwordx4 a[208:211], v1, s[44:47], s84 offen offset:0 sc1
    v_mfma_f32_16x16x32_bf16 v[52:55], a[88:91], a[172:175], v[52:55]
    ds_read_b64 a[86:87], v36 offset:520
    v_mfma_f32_16x16x32_bf16 v[20:23], a[48:51], a[132:135], v[20:23]
    buffer_load_dwordx4 a[240:243], v1, s[44:47], s84 offen offset:1024 sc1
    v_mfma_f32_16x16x32_bf16 v[48:51], a[48:51], a[164:167], v[48:51]
    ds_read_b128 a[232:235], v39 offset:3584
    v_mfma_f32_16x16x32_bf16 v[52:55], a[48:51], a[196:199], v[52:55]
    ds_read_b64 a[116:117], v36 offset:0
    v_mfma_f32_16x16x32_bf16 v[48:51], a[24:27], a[204:207], v[48:51]
    ds_read_b64 a[118:119], v36 offset:8
    v_mfma_f32_16x16x32_bf16 v[52:55], a[56:59], a[204:207], v[52:55]
    ds_read_b64_tr_b16 v[216:217], v65 offset:16384
    v_mfma_f32_16x16x32_bf16 v[48:51], a[80:83], a[132:135], v[48:51]
    ds_read_b64_tr_b16 v[218:219], v65 offset:16896
    v_mfma_f32_16x16x32_bf16 v[52:55], a[80:83], a[164:167], v[52:55]
    ds_read_b64_tr_b16 v[220:221], v65 offset:20480
    v_mfma_f32_16x16x32_bf16 v[52:55], a[24:27], a[236:239], v[52:55]
    ds_read_b64_tr_b16 v[222:223], v65 offset:20992
    s_waitcnt lgkmcnt(15)
    v_mfma_f32_16x16x32_bf16 v[52:55], a[112:115], a[132:135], v[52:55]
    ds_read_b64_tr_b16 v[224:225], v65 offset:24576
    ds_read_b64_tr_b16 v[226:227], v65 offset:25088
    ds_read_b64_tr_b16 v[228:229], v65 offset:28672
    ds_read_b64_tr_b16 v[230:231], v65 offset:29184
    v_mfma_f32_16x16x32_bf16 v[16:19], a[92:95], a[192:195], v[16:19]
    v_mfma_f32_16x16x32_bf16 v[16:19], a[60:63], a[224:227], v[16:19]
    v_mfma_f32_16x16x32_bf16 v[20:23], a[92:95], a[224:227], v[20:23]
    v_mfma_f32_16x16x32_bf16 v[16:19], a[124:127], a[160:163], v[16:19]
    v_mfma_f32_16x16x32_bf16 v[20:23], a[124:127], a[192:195], v[20:23]
    s_waitcnt vmcnt(8)
    v_cmp_ne_u32 vcc, s48, v14
    s_cmp_eq_u64 vcc, 0
    s_cselect_b32 s62, 41943040, 0
    s_waitcnt lgkmcnt(0)
    s_barrier
    v_mfma_f32_16x16x32_bf16 v[48:51], a[124:127], a[224:227], v[48:51]
    s_add_u32 m0, s82, 0
    s_nop 0
    buffer_load_dwordx4 v1, s[60:63], s79 offen offset:0 sc1 lds
    v_mfma_f32_16x16x32_bf16 v[16:19], a[28:31], a[136:139], v[16:19]
    v_mfma_f32_16x16x32_bf16 v[20:23], a[60:63], a[136:139], v[20:23]
    buffer_load_dwordx4 v1, s[60:63], s79 offen offset:1024 sc1 lds
    v_mfma_f32_16x16x32_bf16 v[48:51], a[92:95], a[136:139], v[48:51]
    v_mfma_f32_16x16x32_bf16 v[52:55], a[124:127], a[136:139], v[52:55]
    buffer_load_dwordx4 v1, s[60:63], s79 offen offset:2048 sc1 lds
    v_mfma_f32_16x16x32_bf16 v[16:19], a[20:23], a[128:131], v[16:19]
    v_mfma_f32_16x16x32_bf16 v[20:23], a[20:23], a[160:163], v[20:23]
    buffer_load_dwordx4 v1, s[60:63], s79 offen offset:3072 sc1 lds
    v_mfma_f32_16x16x32_bf16 v[48:51], a[20:23], a[192:195], v[48:51]
    v_mfma_f32_16x16x32_bf16 v[52:55], a[20:23], a[224:227], v[52:55]
    s_add_u32 m0, m0, 4096
    s_nop 0
    buffer_load_dwordx4 v6, s[60:63], s79 offen offset:0 sc1 lds
    v_mfma_f32_16x16x32_bf16 v[20:23], a[28:31], a[168:171], v[20:23]
    v_mfma_f32_16x16x32_bf16 v[48:51], a[60:63], a[168:171], v[48:51]
    buffer_load_dwordx4 v6, s[60:63], s79 offen offset:1024 sc1 lds
    v_mfma_f32_16x16x32_bf16 v[52:55], a[92:95], a[168:171], v[52:55]
    v_mfma_f32_16x16x32_bf16 v[20:23], a[52:55], a[128:131], v[20:23]
    buffer_load_dwordx4 v6, s[60:63], s79 offen offset:2048 sc1 lds
    v_mfma_f32_16x16x32_bf16 v[48:51], a[52:55], a[160:163], v[48:51]
    v_mfma_f32_16x16x32_bf16 v[52:55], a[52:55], a[192:195], v[52:55]
    buffer_load_dwordx4 v6, s[60:63], s79 offen offset:3072 sc1 lds
    v_mfma_f32_16x16x32_bf16 v[48:51], a[28:31], a[200:203], v[48:51]
    v_mfma_f32_16x16x32_bf16 v[52:55], a[60:63], a[200:203], v[52:55]
    s_add_u32 m0, m0, 4096
    s_add_u32 s91, s79, 4096
    buffer_load_dwordx4 v6, s[60:63], s91 offen offset:0 sc1 lds
    v_mfma_f32_16x16x32_bf16 v[48:51], a[84:87], a[128:131], v[48:51]
    v_mfma_f32_16x16x32_bf16 v[52:55], a[84:87], a[160:163], v[52:55]
    buffer_load_dwordx4 v6, s[60:63], s91 offen offset:1024 sc1 lds
    v_mfma_f32_16x16x32_bf16 v[52:55], a[28:31], a[232:235], v[52:55]
    v_mfma_f32_16x16x32_bf16 v[52:55], a[116:119], a[128:131], v[52:55]
    v_cvt_pk_bf16_f32 v56, v16, v17
    v_cvt_pk_bf16_f32 v57, v18, v19
    ds_write_b64 v66, v[56:57] offset:0
    v_cvt_pk_bf16_f32 v58, v20, v21
    v_cvt_pk_bf16_f32 v59, v22, v23
    ds_write_b64 v66, v[58:59] offset:2048
    v_cvt_pk_bf16_f32 v60, v48, v49
    v_cvt_pk_bf16_f32 v61, v50, v51
    ds_write_b64 v66, v[60:61] offset:4096
    v_cvt_pk_bf16_f32 v62, v52, v53
    v_cvt_pk_bf16_f32 v63, v54, v55
    ds_write_b64 v66, v[62:63] offset:6144
    s_waitcnt lgkmcnt(0)
    s_barrier
    ds_read_b64_tr_b16 v[56:57], v67 offset:0
    ds_read_b64_tr_b16 v[58:59], v69 offset:0
    ds_read_b64_tr_b16 v[60:61], v67 offset:4096
    ds_read_b64_tr_b16 v[62:63], v69 offset:4096
    s_waitcnt lgkmcnt(2)
    buffer_store_dwordx4 v[56:59], v68, s[44:47], s80 offen sc1
    s_add_u32 s80, s80, 655360
    s_waitcnt lgkmcnt(0)
    buffer_store_dwordx4 v[60:63], v68, s[44:47], s80 offen sc1
    s_add_u32 s80, s80, 655360
    s_add_u32 s86, s81, 81920
    s_waitcnt vmcnt(0)
    s_mov_b64 exec, 1
    buffer_store_dword v15, off, s[44:47], s81 sc1
    s_mov_b64 exec, -1
    s_mov_b64 exec, 1
    buffer_store_dword v15, off, s[44:47], s86 sc1
    s_mov_b64 exec, -1
G1_LATE:
    buffer_load_dwordx4 a[16:19], v1, s[44:47], s84 offen offset:2048 sc1
    buffer_load_dwordx4 a[48:51], v1, s[44:47], s84 offen offset:3072 sc1
    s_add_u32 s84, s84, 4096
    buffer_load_dwordx4 a[80:83], v1, s[44:47], s84 offen offset:0 sc1
    buffer_load_dwordx4 a[112:115], v1, s[44:47], s84 offen offset:1024 sc1
    buffer_load_dwordx4 a[140:143], v1, s[44:47], s84 offen offset:2048 sc1
    buffer_load_dwordx4 a[172:175], v1, s[44:47], s84 offen offset:3072 sc1
    s_add_u32 s84, s84, 4096
    buffer_load_dwordx4 a[204:207], v1, s[44:47], s84 offen offset:0 sc1
    buffer_load_dwordx4 a[236:239], v1, s[44:47], s84 offen offset:1024 sc1
    buffer_load_dwordx4 a[24:27], v1, s[44:47], s84 offen offset:2048 sc1
    buffer_load_dwordx4 a[56:59], v1, s[44:47], s84 offen offset:3072 sc1
    s_add_u32 s84, s84, 4096
    buffer_load_dwordx4 a[88:91], v1, s[44:47], s84 offen offset:0 sc1
    buffer_load_dwordx4 a[120:123], v1, s[44:47], s84 offen offset:1024 sc1
    buffer_load_dwordx4 a[132:135], v1, s[44:47], s84 offen offset:2048 sc1
    buffer_load_dwordx4 a[164:167], v1, s[44:47], s84 offen offset:3072 sc1
    s_add_u32 s84, s84, 4096
    buffer_load_dwordx4 a[196:199], v1, s[44:47], s84 offen offset:0 sc1
    buffer_load_dwordx4 a[228:231], v1, s[44:47], s84 offen offset:1024 sc1
    buffer_load_dwordx4 a[20:23], v1, s[44:47], s84 offen offset:2048 sc1
    buffer_load_dwordx4 a[52:55], v1, s[44:47], s84 offen offset:3072 sc1
    s_add_u32 s84, s84, 4096
    buffer_load_dwordx4 a[84:87], v1, s[44:47], s84 offen offset:0 sc1
    buffer_load_dwordx4 a[116:119], v1, s[44:47], s84 offen offset:1024 sc1
    buffer_load_dwordx4 a[136:139], v1, s[44:47], s84 offen offset:2048 sc1
    buffer_load_dwordx4 a[168:171], v1, s[44:47], s84 offen offset:3072 sc1
    s_add_u32 s84, s84, 4096
    buffer_load_dwordx4 a[200:203], v1, s[28:31], s84 offen offset:0 sc1
    buffer_load_dwordx4 a[232:235], v1, s[28:31], s84 offen offset:1024 sc1
    buffer_load_dwordx4 a[28:31], v1, s[28:31], s84 offen offset:2048 sc1
    buffer_load_dwordx4 a[60:63], v1, s[28:31], s84 offen offset:3072 sc1
    s_add_u32 s84, s84, 4096
    buffer_load_dwordx4 a[92:95], v1, s[28:31], s84 offen offset:0 sc1
    buffer_load_dwordx4 a[124:127], v1, s[28:31], s84 offen offset:1024 sc1
    buffer_load_dwordx4 a[128:131], v1, s[28:31], s84 offen offset:2048 sc1
    buffer_load_dwordx4 a[160:163], v1, s[28:31], s84 offen offset:3072 sc1
    s_add_u32 s84, s84, 4096
    buffer_load_dwordx4 a[192:195], v1, s[28:31], s84 offen offset:0 sc1
    buffer_load_dwordx4 a[224:227], v1, s[28:31], s84 offen offset:1024 sc1
    s_cmp_lg_u32 s62, 0
    s_cbranch_scc1 G1_MAIN
    s_call_b64 s[92:93], A_LATE
G1_MAIN:
    s_mov_b32 s68, 0
    s_lshl_b32 s88, s55, 2
    s_add_u32 s88, s88, s49
    s_mul_i32 s87, s54, 229376
    s_lshl_b32 s89, s88, 9
    s_add_u32 s87, s87, s89
    s_add_u32 s71, s87, 24117248
    s_mul_i32 s86, s54, 112
    s_add_u32 s86, s86, s88
    s_lshl_b32 s86, s86, 7
    s_add_u32 s76, s86, 626688
    s_mov_b32 s74, 0
    s_lshl_b32 s86, s74, 3
    s_add_u32 s86, s86, s50
    s_mul_i32 s86, s86, 112
    s_mul_i32 s87, s49, 28
    s_add_u32 s86, s86, s87
    s_lshl_b32 s86, s86, 7
    s_and_b32 s87, s52, 2
    s_lshl_b32 s87, s87, 5
    s_add_u32 s86, s86, s87
    s_add_u32 s73, s86, 626688
    s_lshl_b32 s86, s74, 5
    s_add_u32 s86, s86, s52
    s_mul_i32 s87, s86, 57344
    s_mul_i32 s88, s49, 14336
    s_add_u32 s87, s87, s88
    s_add_u32 s75, s87, 24117248
    s_mul_i32 s88, s53, 2560
    s_mul_i32 s89, s49, 640
    s_add_u32 s88, s88, s89
    s_mul_i32 s87, s86, 20480
    s_add_u32 s87, s87, s88
    s_add_u32 s78, s87, 14680064
    s_add_u32 s80, s87, 20578304
    s_and_b32 s86, s86, 127
    s_mul_i32 s87, s86, 20480
    s_mul_i32 s88, s53, 160
    s_add_u32 s6, s87, s88
    s_cmp_ge_u32 s74, 4
    s_cselect_b32 s80, s6, s80
    s_mov_b32 s56, s44
    s_mov_b32 s57, s45
    s_cselect_b32 s58, 0, s46
    s_cselect_b32 s42, 2621440, 0
    s_cselect_b32 s10, 41943040, 0
    s_sub_u32 s80, s80, 655360
    s_sub_u32 s78, s78, 655360
    s_sub_u32 s75, s75, s34
    s_waitcnt vmcnt(2)
    s_barrier
    ds_read_b128 v[56:59], v2 offset:0
    ds_read_b128 v[48:51], v3 offset:0
    s_waitcnt lgkmcnt(1)
    v_mfma_f32_32x32x16_bf16 v[16:31], v[72:75], v[56:59], 0
    ds_read_b128 v[52:55], v4 offset:0
    ds_read_b128 v[60:63], v5 offset:0
    s_add_u32 m0, s82, 40960
    s_nop 0
    buffer_load_dwordx4 v1, s[44:47], s70 offen offset:0 sc1 lds
    s_waitcnt lgkmcnt(2)
    v_mfma_f32_32x32x16_bf16 v[16:31], v[76:79], v[48:51], v[16:31]
    ds_read_b128 v[56:59], v2 offset:1024
    s_waitcnt lgkmcnt(2)
    v_mfma_f32_32x32x16_bf16 v[16:31], v[80:83], v[52:55], v[16:31]
    ds_read_b128 v[48:51], v3 offset:1024
    buffer_load_dwordx4 v1, s[44:47], s70 offen offset:1024 sc1 lds
    s_waitcnt lgkmcnt(2)
    v_mfma_f32_32x32x16_bf16 v[16:31], v[84:87], v[60:63], v[16:31]
    ds_read_b128 v[52:55], v4 offset:1024
    s_waitcnt lgkmcnt(2)
    v_mfma_f32_32x32x16_bf16 v[16:31], v[88:91], v[56:59], v[16:31]
    ds_read_b128 v[60:63], v5 offset:1024
    buffer_load_dwordx4 v1, s[44:47], s70 offen offset:2048 sc1 lds
    s_waitcnt lgkmcnt(2)
    v_mfma_f32_32x32x16_bf16 v[16:31], v[92:95], v[48:51], v[16:31]
    ds_read_b128 v[56:59], v2 offset:2048
    s_waitcnt lgkmcnt(2)
    v_mfma_f32_32x32x16_bf16 v[16:31], v[96:99], v[52:55], v[16:31]
    ds_read_b128 v[48:51], v3 offset:2048
    buffer_load_dwordx4 v1, s[44:47], s70 offen offset:3072 sc1 lds
    s_waitcnt lgkmcnt(2)
    v_mfma_f32_32x32x16_bf16 v[16:31], v[100:103], v[60:63], v[16:31]
    ds_read_b128 v[52:55], v4 offset:2048
    s_waitcnt lgkmcnt(2)
    v_mfma_f32_32x32x16_bf16 v[16:31], v[104:107], v[56:59], v[16:31]
    ds_read_b128 v[60:63], v5 offset:2048
    s_add_u32 m0, m0, 4096
    s_nop 0
    buffer_load_dwordx4 v6, s[44:47], s70 offen offset:0 sc1 lds
    s_waitcnt lgkmcnt(2)
    v_mfma_f32_32x32x16_bf16 v[16:31], v[108:111], v[48:51], v[16:31]
    ds_read_b128 v[56:59], v2 offset:3072
    s_waitcnt lgkmcnt(2)
    v_mfma_f32_32x32x16_bf16 v[16:31], v[112:115], v[52:55], v[16:31]
    ds_read_b128 v[48:51], v3 offset:3072
    buffer_load_dwordx4 v6, s[44:47], s70 offen offset:1024 sc1 lds
    s_waitcnt lgkmcnt(2)
    v_mfma_f32_32x32x16_bf16 v[16:31], v[116:119], v[60:63], v[16:31]
    ds_read_b128 v[52:55], v4 offset:3072
    s_waitcnt lgkmcnt(2)
    v_mfma_f32_32x32x16_bf16 v[16:31], v[120:123], v[56:59], v[16:31]
    ds_read_b128 v[60:63], v5 offset:3072
    buffer_load_dwordx4 v6, s[44:47], s70 offen offset:2048 sc1 lds
    s_waitcnt lgkmcnt(2)
    v_mfma_f32_32x32x16_bf16 v[16:31], v[124:127], v[48:51], v[16:31]
    ds_read_b128 v[56:59], v2 offset:4096
    s_waitcnt lgkmcnt(2)
    v_mfma_f32_32x32x16_bf16 v[16:31], v[128:131], v[52:55], v[16:31]
    ds_read_b128 v[48:51], v3 offset:4096
    buffer_load_dwordx4 v6, s[44:47], s70 offen offset:3072 sc1 lds
    s_waitcnt lgkmcnt(2)
    v_mfma_f32_32x32x16_bf16 v[16:31], v[132:135], v[60:63], v[16:31]
    ds_read_b128 v[52:55], v4 offset:4096
    s_waitcnt lgkmcnt(2)
    v_mfma_f32_32x32x16_bf16 v[16:31], v[136:139], v[56:59], v[16:31]
    ds_read_b128 v[60:63], v5 offset:4096
    s_add_u32 m0, m0, 4096
    s_add_u32 s91, s70, 4096
    buffer_load_dwordx4 v6, s[44:47], s91 offen offset:0 sc1 lds
    s_waitcnt lgkmcnt(2)
    v_mfma_f32_32x32x16_bf16 v[16:31], v[140:143], v[48:51], v[16:31]
    ds_read_b128 v[56:59], v2 offset:5120
    s_waitcnt lgkmcnt(2)
    v_mfma_f32_32x32x16_bf16 v[16:31], v[144:147], v[52:55], v[16:31]
    ds_read_b128 v[48:51], v3 offset:5120
    buffer_load_dwordx4 v6, s[44:47], s91 offen offset:1024 sc1 lds
    s_waitcnt lgkmcnt(2)
    v_mfma_f32_32x32x16_bf16 v[16:31], v[148:151], v[60:63], v[16:31]
    ds_read_b128 v[52:55], v4 offset:5120
    s_waitcnt lgkmcnt(2)
    v_mfma_f32_32x32x16_bf16 v[16:31], v[152:155], v[56:59], v[16:31]
    ds_read_b128 v[60:63], v5 offset:5120
    s_waitcnt lgkmcnt(2)
    v_mfma_f32_32x32x16_bf16 v[16:31], v[156:159], v[48:51], v[16:31]
    ds_read_b128 v[56:59], v2 offset:6144
    s_waitcnt lgkmcnt(2)
    v_mfma_f32_32x32x16_bf16 v[16:31], v[160:163], v[52:55], v[16:31]
    ds_read_b128 v[48:51], v3 offset:6144
    s_waitcnt lgkmcnt(2)
    v_mfma_f32_32x32x16_bf16 v[16:31], v[164:167], v[60:63], v[16:31]
    ds_read_b128 v[52:55], v4 offset:6144
    s_waitcnt lgkmcnt(2)
    v_mfma_f32_32x32x16_bf16 v[16:31], v[168:171], v[56:59], v[16:31]
    ds_read_b128 v[60:63], v5 offset:6144
    s_waitcnt lgkmcnt(2)
    v_mfma_f32_32x32x16_bf16 v[16:31], v[172:175], v[48:51], v[16:31]
    ds_read_b128 v[56:59], v2 offset:7168
    s_waitcnt lgkmcnt(2)
    v_mfma_f32_32x32x16_bf16 v[16:31], v[176:179], v[52:55], v[16:31]
    ds_read_b128 v[48:51], v3 offset:7168
    s_waitcnt lgkmcnt(2)
    v_mfma_f32_32x32x16_bf16 v[16:31], v[180:183], v[60:63], v[16:31]
    ds_read_b128 v[52:55], v4 offset:7168
    s_waitcnt lgkmcnt(2)
    v_mfma_f32_32x32x16_bf16 v[16:31], v[184:187], v[56:59], v[16:31]
    ds_read_b128 v[60:63], v5 offset:7168
    s_waitcnt lgkmcnt(2)
    v_mfma_f32_32x32x16_bf16 v[16:31], v[188:191], v[48:51], v[16:31]
    ds_read_b128 v[56:59], v2 offset:8192
    s_waitcnt lgkmcnt(2)
    v_mfma_f32_32x32x16_bf16 v[16:31], v[192:195], v[52:55], v[16:31]
    ds_read_b128 v[48:51], v3 offset:8192
    s_add_u32 s77, s77, 16384
    s_min_u32 s77, s77, 577536
    s_waitcnt lgkmcnt(2)
    v_mfma_f32_32x32x16_bf16 v[16:31], v[196:199], v[60:63], v[16:31]
    ds_read_b128 v[52:55], v4 offset:8192
    s_add_u32 s79, s79, 655360
    s_add_u32 s70, s70, 655360
    s_waitcnt lgkmcnt(2)
    v_mfma_f32_32x32x16_bf16 v[16:31], v[200:203], v[56:59], v[16:31]
    ds_read_b128 v[60:63], v5 offset:8192
    s_waitcnt lgkmcnt(2)
    v_mfma_f32_32x32x16_bf16 v[16:31], v[204:207], v[48:51], v[16:31]
    ds_read_b128 v[56:59], v2 offset:9216
    s_waitcnt lgkmcnt(2)
    v_mfma_f32_32x32x16_bf16 v[16:31], v[208:211], v[52:55], v[16:31]
    ds_read_b128 v[48:51], v3 offset:9216
    s_waitcnt lgkmcnt(2)
    v_mfma_f32_32x32x16_bf16 v[16:31], v[212:215], v[60:63], v[16:31]
    ds_read_b128 v[52:55], v4 offset:9216
    s_waitcnt lgkmcnt(2)
    v_mfma_f32_32x32x16_bf16 v[16:31], v[216:219], v[56:59], v[16:31]
    ds_read_b128 v[60:63], v5 offset:9216
    s_waitcnt vmcnt(0)
    s_barrier
    s_waitcnt lgkmcnt(2)
    v_mfma_f32_32x32x16_bf16 v[16:31], v[220:223], v[48:51], v[16:31]
    ds_read_b128 v[56:59], v2 offset:40960
    s_waitcnt lgkmcnt(2)
    v_mfma_f32_32x32x16_bf16 v[16:31], v[224:227], v[52:55], v[16:31]
    ds_read_b128 v[48:51], v3 offset:40960
    s_waitcnt lgkmcnt(2)
    v_mfma_f32_32x32x16_bf16 v[16:31], v[228:231], v[60:63], v[16:31]
    ds_read_b128 v[52:55], v4 offset:40960
    s_waitcnt lgkmcnt(2)
    v_mfma_f32_32x32x16_bf16 v[32:47], v[72:75], v[56:59], 0
    ds_read_b128 v[60:63], v5 offset:40960
    s_waitcnt lgkmcnt(2)
    v_mfma_f32_32x32x16_bf16 v[32:47], v[76:79], v[48:51], v[32:47]
    ds_read_b128 v[56:59], v2 offset:41984
    v_fma_f32 v68, v16, v16, s100
    v_fma_f32 v69, v17, v17, s100
    v_fma_f32 v70, v18, v18, s100
    s_waitcnt lgkmcnt(2)
    v_mfma_f32_32x32x16_bf16 v[32:47], v[80:83], v[52:55], v[32:47]
    ds_read_b128 v[48:51], v3 offset:41984
    v_fma_f32 v71, v19, v19, s100
    v_mul_f32 v24, v24, v16
    s_waitcnt lgkmcnt(2)
    v_mfma_f32_32x32x16_bf16 v[32:47], v[84:87], v[60:63], v[32:47]
    ds_read_b128 v[52:55], v4 offset:41984
    v_mul_f32 v25, v25, v17
    v_mul_f32 v26, v26, v18
    s_waitcnt lgkmcnt(2)
    v_mfma_f32_32x32x16_bf16 v[32:47], v[88:91], v[56:59], v[32:47]
    ds_read_b128 v[60:63], v5 offset:41984
    v_mul_f32 v27, v27, v19
    v_mul_f32 v16, v16, v68
    s_waitcnt lgkmcnt(2)
    v_mfma_f32_32x32x16_bf16 v[32:47], v[92:95], v[48:51], v[32:47]
    ds_read_b128 v[56:59], v2 offset:43008
    v_mul_f32 v17, v17, v69
    v_mul_f32 v18, v18, v70
    s_waitcnt lgkmcnt(2)
    v_mfma_f32_32x32x16_bf16 v[32:47], v[96:99], v[52:55], v[32:47]
    ds_read_b128 v[48:51], v3 offset:43008
    v_mul_f32 v19, v19, v71
    v_exp_f32 v16, -v16
    s_waitcnt lgkmcnt(2)
    v_mfma_f32_32x32x16_bf16 v[32:47], v[100:103], v[60:63], v[32:47]
    ds_read_b128 v[52:55], v4 offset:43008
    v_exp_f32 v17, -v17
    v_exp_f32 v18, -v18
    s_waitcnt lgkmcnt(2)
    v_mfma_f32_32x32x16_bf16 v[32:47], v[104:107], v[56:59], v[32:47]
    ds_read_b128 v[60:63], v5 offset:43008
    v_exp_f32 v19, -v19
    v_add_f32 v16, 1.0, v16
    v_add_f32 v17, 1.0, v17
    s_waitcnt lgkmcnt(2)
    v_mfma_f32_32x32x16_bf16 v[32:47], v[108:111], v[48:51], v[32:47]
    ds_read_b128 v[56:59], v2 offset:44032
    v_add_f32 v18, 1.0, v18
    v_add_f32 v19, 1.0, v19
    s_waitcnt lgkmcnt(2)
    v_mfma_f32_32x32x16_bf16 v[32:47], v[112:115], v[52:55], v[32:47]
    ds_read_b128 v[48:51], v3 offset:44032
    v_rcp_f32 v16, v16
    v_rcp_f32 v17, v17
    s_waitcnt lgkmcnt(2)
    v_mfma_f32_32x32x16_bf16 v[32:47], v[116:119], v[60:63], v[32:47]
    ds_read_b128 v[52:55], v4 offset:44032
    v_rcp_f32 v18, v18
    v_rcp_f32 v19, v19
    s_waitcnt lgkmcnt(2)
    v_mfma_f32_32x32x16_bf16 v[32:47], v[120:123], v[56:59], v[32:47]
    ds_read_b128 v[60:63], v5 offset:44032
    v_mul_f32 v24, v24, v16
    v_mul_f32 v25, v25, v17
    s_waitcnt lgkmcnt(2)
    v_mfma_f32_32x32x16_bf16 v[32:47], v[124:127], v[48:51], v[32:47]
    ds_read_b128 v[56:59], v2 offset:45056
    v_mul_f32 v26, v26, v18
    v_mul_f32 v27, v27, v19
    s_waitcnt lgkmcnt(2)
    v_mfma_f32_32x32x16_bf16 v[32:47], v[128:131], v[52:55], v[32:47]
    ds_read_b128 v[48:51], v3 offset:45056
    v_cvt_pk_bf16_f32 v64, v24, v25
    v_cvt_pk_bf16_f32 v65, v26, v27
    s_waitcnt lgkmcnt(2)
    v_mfma_f32_32x32x16_bf16 v[32:47], v[132:135], v[60:63], v[32:47]
    ds_read_b128 v[52:55], v4 offset:45056
    v_fma_f32 v68, v20, v20, s100
    v_fma_f32 v69, v21, v21, s100
    v_fma_f32 v70, v22, v22, s100
    s_waitcnt lgkmcnt(2)
    v_mfma_f32_32x32x16_bf16 v[32:47], v[136:139], v[56:59], v[32:47]
    ds_read_b128 v[60:63], v5 offset:45056
    v_fma_f32 v71, v23, v23, s100
    v_mul_f32 v28, v28, v20
    s_waitcnt lgkmcnt(2)
    v_mfma_f32_32x32x16_bf16 v[32:47], v[140:143], v[48:51], v[32:47]
    ds_read_b128 v[56:59], v2 offset:46080
    v_mul_f32 v29, v29, v21
    v_mul_f32 v30, v30, v22
    s_waitcnt lgkmcnt(2)
    v_mfma_f32_32x32x16_bf16 v[32:47], v[144:147], v[52:55], v[32:47]
    ds_read_b128 v[48:51], v3 offset:46080
    v_mul_f32 v31, v31, v23
    v_mul_f32 v20, v20, v68
    s_waitcnt lgkmcnt(2)
    v_mfma_f32_32x32x16_bf16 v[32:47], v[148:151], v[60:63], v[32:47]
    ds_read_b128 v[52:55], v4 offset:46080
    v_mul_f32 v21, v21, v69
    v_mul_f32 v22, v22, v70
    s_waitcnt lgkmcnt(2)
    v_mfma_f32_32x32x16_bf16 v[32:47], v[152:155], v[56:59], v[32:47]
    ds_read_b128 v[60:63], v5 offset:46080
    v_mul_f32 v23, v23, v71
    v_exp_f32 v20, -v20
    s_waitcnt lgkmcnt(2)
    v_mfma_f32_32x32x16_bf16 v[32:47], v[156:159], v[48:51], v[32:47]
    ds_read_b128 v[56:59], v2 offset:47104
    v_exp_f32 v21, -v21
    v_exp_f32 v22, -v22
    s_waitcnt lgkmcnt(2)
    v_mfma_f32_32x32x16_bf16 v[32:47], v[160:163], v[52:55], v[32:47]
    ds_read_b128 v[48:51], v3 offset:47104
    v_exp_f32 v23, -v23
    v_add_f32 v20, 1.0, v20
    v_add_f32 v21, 1.0, v21
    s_waitcnt lgkmcnt(2)
    v_mfma_f32_32x32x16_bf16 v[32:47], v[164:167], v[60:63], v[32:47]
    ds_read_b128 v[52:55], v4 offset:47104
    v_add_f32 v22, 1.0, v22
    v_add_f32 v23, 1.0, v23
    s_waitcnt lgkmcnt(2)
    v_mfma_f32_32x32x16_bf16 v[32:47], v[168:171], v[56:59], v[32:47]
    ds_read_b128 v[60:63], v5 offset:47104
    buffer_load_dword v14, v10, s[44:47], s77 offen sc1
    v_rcp_f32 v20, v20
    v_rcp_f32 v21, v21
    s_waitcnt lgkmcnt(2)
    v_mfma_f32_32x32x16_bf16 v[32:47], v[172:175], v[48:51], v[32:47]
    ds_read_b128 v[56:59], v2 offset:48128
    v_rcp_f32 v22, v22
    v_rcp_f32 v23, v23
    s_waitcnt lgkmcnt(2)
    v_mfma_f32_32x32x16_bf16 v[32:47], v[176:179], v[52:55], v[32:47]
    ds_read_b128 v[48:51], v3 offset:48128
    v_mul_f32 v28, v28, v20
    v_mul_f32 v29, v29, v21
    s_waitcnt lgkmcnt(2)
    v_mfma_f32_32x32x16_bf16 v[32:47], v[180:183], v[60:63], v[32:47]
    ds_read_b128 v[52:55], v4 offset:48128
    v_mul_f32 v30, v30, v22
    v_mul_f32 v31, v31, v23
    s_waitcnt lgkmcnt(2)
    v_mfma_f32_32x32x16_bf16 v[32:47], v[184:187], v[56:59], v[32:47]
    ds_read_b128 v[60:63], v5 offset:48128
    v_cvt_pk_bf16_f32 v66, v28, v29
    v_cvt_pk_bf16_f32 v67, v30, v31
    s_waitcnt lgkmcnt(2)
    v_mfma_f32_32x32x16_bf16 v[32:47], v[188:191], v[48:51], v[32:47]
    ds_read_b128 v[56:59], v2 offset:49152
    s_waitcnt lgkmcnt(2)
    v_mfma_f32_32x32x16_bf16 v[32:47], v[192:195], v[52:55], v[32:47]
    ds_read_b128 v[48:51], v3 offset:49152
    buffer_store_dwordx4 v[64:67], v8, s[44:47], s71 offen sc1
    s_add_u32 s71, s71, 114688
    s_waitcnt lgkmcnt(2)
    v_mfma_f32_32x32x16_bf16 v[32:47], v[196:199], v[60:63], v[32:47]
    ds_read_b128 v[52:55], v4 offset:49152
    s_waitcnt lgkmcnt(2)
    v_mfma_f32_32x32x16_bf16 v[32:47], v[200:203], v[56:59], v[32:47]
    ds_read_b128 v[60:63], v5 offset:49152
    s_waitcnt lgkmcnt(2)
    v_mfma_f32_32x32x16_bf16 v[32:47], v[204:207], v[48:51], v[32:47]
    ds_read_b128 v[56:59], v2 offset:50176
    s_waitcnt lgkmcnt(2)
    v_mfma_f32_32x32x16_bf16 v[32:47], v[208:211], v[52:55], v[32:47]
    ds_read_b128 v[48:51], v3 offset:50176
    s_waitcnt lgkmcnt(2)
    v_mfma_f32_32x32x16_bf16 v[32:47], v[212:215], v[60:63], v[32:47]
    ds_read_b128 v[52:55], v4 offset:50176
    s_waitcnt lgkmcnt(2)
    v_mfma_f32_32x32x16_bf16 v[32:47], v[216:219], v[56:59], v[32:47]
    ds_read_b128 v[60:63], v5 offset:50176
    s_waitcnt vmcnt(1)
    v_cmp_ne_u32 vcc, s48, v14
    s_cmp_eq_u64 vcc, 0
    s_cselect_b32 s62, 41943040, 0
    s_cmp_eq_u32 s68, 7
    s_cselect_b32 s62, 0, s62
    s_waitcnt lgkmcnt(2)
    v_mfma_f32_32x32x16_bf16 v[32:47], v[220:223], v[48:51], v[32:47]
    s_add_u32 m0, s82, 0
    s_nop 0
    buffer_load_dwordx4 v1, s[60:63], s79 offen offset:0 sc1 lds
    s_waitcnt lgkmcnt(1)
    v_mfma_f32_32x32x16_bf16 v[32:47], v[224:227], v[52:55], v[32:47]
    s_waitcnt lgkmcnt(0)
    v_mfma_f32_32x32x16_bf16 v[32:47], v[228:231], v[60:63], v[32:47]
    buffer_load_dwordx4 v1, s[60:63], s79 offen offset:1024 sc1 lds
    buffer_load_dwordx4 v1, s[60:63], s79 offen offset:2048 sc1 lds
    s_nop 9
    v_pk_fma_f32 v[64:65], v[32:33], v[32:33], s[100:101] op_sel_hi:[1,1,0]
    v_pk_fma_f32 v[66:67], v[34:35], v[34:35], s[100:101] op_sel_hi:[1,1,0]
    v_pk_fma_f32 v[68:69], v[36:37], v[36:37], s[100:101] op_sel_hi:[1,1,0]
    v_pk_fma_f32 v[70:71], v[38:39], v[38:39], s[100:101] op_sel_hi:[1,1,0]
    v_pk_mul_f32 v[40:41], v[32:33], v[40:41]
    buffer_load_dwordx4 v1, s[60:63], s79 offen offset:3072 sc1 lds
    v_pk_mul_f32 v[42:43], v[34:35], v[42:43]
    v_pk_mul_f32 v[44:45], v[36:37], v[44:45]
    v_pk_mul_f32 v[46:47], v[38:39], v[46:47]
    v_pk_mul_f32 v[32:33], v[32:33], v[64:65]
    v_pk_mul_f32 v[34:35], v[34:35], v[66:67]
    s_add_u32 m0, m0, 4096
    s_nop 0
    buffer_load_dwordx4 v6, s[60:63], s79 offen offset:0 sc1 lds
    v_pk_mul_f32 v[36:37], v[36:37], v[68:69]
    v_pk_mul_f32 v[38:39], v[38:39], v[70:71]
    v_exp_f32 v32, -v32
    v_exp_f32 v33, -v33
    v_exp_f32 v34, -v34
    buffer_load_dwordx4 v6, s[60:63], s79 offen offset:1024 sc1 lds
    v_exp_f32 v35, -v35
    v_exp_f32 v36, -v36
    v_exp_f32 v37, -v37
    v_exp_f32 v38, -v38
    v_exp_f32 v39, -v39
    buffer_load_dwordx4 v6, s[60:63], s79 offen offset:2048 sc1 lds
    v_pk_add_f32 v[32:33], v[32:33], 1.0 op_sel_hi:[1,0]
    v_pk_add_f32 v[34:35], v[34:35], 1.0 op_sel_hi:[1,0]
    v_pk_add_f32 v[36:37], v[36:37], 1.0 op_sel_hi:[1,0]
    v_pk_add_f32 v[38:39], v[38:39], 1.0 op_sel_hi:[1,0]
    v_rcp_f32 v32, v32
    buffer_load_dwordx4 v6, s[60:63], s79 offen offset:3072 sc1 lds
    v_rcp_f32 v33, v33
    v_rcp_f32 v34, v34
    v_rcp_f32 v35, v35
    v_rcp_f32 v36, v36
    v_rcp_f32 v37, v37
    s_add_u32 m0, m0, 4096
    s_add_u32 s91, s79, 4096
    buffer_load_dwordx4 v6, s[60:63], s91 offen offset:0 sc1 lds
    v_rcp_f32 v38, v38
    v_rcp_f32 v39, v39
    v_pk_mul_f32 v[40:41], v[40:41], v[32:33]
    v_pk_mul_f32 v[42:43], v[42:43], v[34:35]
    v_pk_mul_f32 v[44:45], v[44:45], v[36:37]
    buffer_load_dwordx4 v6, s[60:63], s91 offen offset:1024 sc1 lds
    v_pk_mul_f32 v[46:47], v[46:47], v[38:39]
    v_cvt_pk_bf16_f32 v64, v40, v41
    v_cvt_pk_bf16_f32 v65, v42, v43
    v_cvt_pk_bf16_f32 v66, v44, v45
    v_cvt_pk_bf16_f32 v67, v46, v47
    buffer_store_dwordx4 v[64:67], v8, s[44:47], s71 offen sc1
    s_add_u32 s71, s71, 1720320
    s_waitcnt vmcnt(11)
    s_mov_b64 exec, 1
    buffer_store_dword v15, off, s[44:47], s76 sc1
    s_mov_b64 exec, -1
    s_cmp_lg_u32 s62, 0
    s_cbranch_scc1 ONTIME_13
    s_cmp_eq_u32 s68, 7
    s_cbranch_scc1 ONTIME_13
    s_call_b64 s[92:93], A_LATE
ONTIME_13:
    s_waitcnt vmcnt(2)
    s_barrier
    ds_read_b128 v[56:59], v2 offset:0
    ds_read_b128 v[48:51], v3 offset:0
    s_add_u32 s68, s68, 1
    s_waitcnt lgkmcnt(0)
G1_LOOP:
    s_waitcnt lgkmcnt(5)
    v_mfma_f32_32x32x16_bf16 v[16:31], v[72:75], v[56:59], 0
    ds_read_b128 v[52:55], v4 offset:0
    ds_write_b128 v11, v[60:63] offset:256
    ds_read_b128 v[60:63], v5 offset:0
    s_waitcnt lgkmcnt(7)
    v_mfma_f32_32x32x16_bf16 v[16:31], v[76:79], v[48:51], v[16:31]
    ds_read_b128 v[56:59], v2 offset:1024
    s_waitcnt lgkmcnt(3)
    v_mfma_f32_32x32x16_bf16 v[16:31], v[80:83], v[52:55], v[16:31]
    ds_read_b128 v[48:51], v3 offset:1024
    s_waitcnt lgkmcnt(3)
    s_waitcnt vmcnt(0)
    s_barrier
    ds_read_b128 v[32:35], v12 offset:0
    s_waitcnt lgkmcnt(3)
    v_mfma_f32_32x32x16_bf16 v[16:31], v[84:87], v[60:63], v[16:31]
    ds_read_b128 v[52:55], v4 offset:1024
    s_mov_b64 exec, 1
    buffer_store_dword v15, off, s[44:47], s76 offset:64 sc1
    s_mov_b64 exec, -1
    ds_read_b128 v[40:43], v12 offset:5376
    ds_read_b128 v[36:39], v12 offset:16
    s_add_u32 m0, s82, 40960
    s_nop 0
    buffer_load_dwordx4 v1, s[44:47], s70 offen offset:0 sc1 lds
    s_waitcnt lgkmcnt(5)
    v_mfma_f32_32x32x16_bf16 v[16:31], v[88:91], v[56:59], v[16:31]
    ds_read_b128 v[60:63], v5 offset:1024
    ds_read_b128 v[44:47], v12 offset:5392
    ds_read_b128 v[64:67], v12 offset:10752
    buffer_load_dwordx4 v1, s[44:47], s70 offen offset:1024 sc1 lds
    s_waitcnt lgkmcnt(7)
    v_mfma_f32_32x32x16_bf16 v[16:31], v[92:95], v[48:51], v[16:31]
    ds_read_b128 v[56:59], v2 offset:2048
    ds_read_b128 v[68:71], v12 offset:10768
    buffer_load_dwordx4 v1, s[44:47], s70 offen offset:2048 sc1 lds
    s_waitcnt lgkmcnt(7)
    v_mfma_f32_32x32x16_bf16 v[16:31], v[96:99], v[52:55], v[16:31]
    ds_read_b128 v[48:51], v3 offset:2048
    s_cmp_eq_u32 s68, 6
    s_cselect_b32 s80, s6, s80
    s_cselect_b32 s58, 0, s58
    s_cselect_b32 s42, 2621440, s42
    buffer_load_dwordx4 v1, s[44:47], s70 offen offset:3072 sc1 lds
    s_waitcnt lgkmcnt(5)
    v_mfma_f32_32x32x16_bf16 v[16:31], v[100:103], v[60:63], v[16:31]
    ds_read_b128 v[52:55], v4 offset:2048
    v_add_f32 v32, v32, v40
    v_add_f32 v33, v33, v41
    v_add_f32 v34, v34, v42
    v_add_f32 v35, v35, v43
    s_add_u32 m0, m0, 4096
    s_nop 0
    buffer_load_dwordx4 v6, s[44:47], s70 offen offset:0 sc1 lds
    s_waitcnt lgkmcnt(3)
    v_mfma_f32_32x32x16_bf16 v[16:31], v[104:107], v[56:59], v[16:31]
    ds_read_b128 v[60:63], v5 offset:2048
    v_add_f32 v36, v36, v44
    v_add_f32 v37, v37, v45
    v_add_f32 v38, v38, v46
    v_add_f32 v39, v39, v47
    buffer_load_dwordx4 v6, s[44:47], s70 offen offset:1024 sc1 lds
    s_waitcnt lgkmcnt(2)
    v_mfma_f32_32x32x16_bf16 v[16:31], v[108:111], v[48:51], v[16:31]
    ds_read_b128 v[56:59], v2 offset:3072
    ds_read_b128 v[40:43], v12 offset:16128
    ds_read_b128 v[44:47], v12 offset:16144
    v_add_f32 v32, v32, v64
    buffer_load_dwordx4 v6, s[44:47], s70 offen offset:2048 sc1 lds
    s_waitcnt lgkmcnt(4)
    v_mfma_f32_32x32x16_bf16 v[16:31], v[112:115], v[52:55], v[16:31]
    ds_read_b128 v[48:51], v3 offset:3072
    v_add_f32 v33, v33, v65
    v_add_f32 v34, v34, v66
    v_add_f32 v35, v35, v67
    v_add_f32 v36, v36, v68
    buffer_load_dwordx4 v6, s[44:47], s70 offen offset:3072 sc1 lds
    s_waitcnt lgkmcnt(4)
    v_mfma_f32_32x32x16_bf16 v[16:31], v[116:119], v[60:63], v[16:31]
    ds_read_b128 v[52:55], v4 offset:3072
    v_add_f32 v37, v37, v69
    v_add_f32 v38, v38, v70
    v_add_f32 v39, v39, v71
    ds_read_b128 v[64:67], v7 offset:14336
    s_add_u32 m0, m0, 4096
    s_add_u32 s91, s70, 4096
    buffer_load_dwordx4 v6, s[44:47], s91 offen offset:0 sc1 lds
    s_waitcnt lgkmcnt(5)
    v_mfma_f32_32x32x16_bf16 v[16:31], v[120:123], v[56:59], v[16:31]
    ds_read_b128 v[60:63], v5 offset:3072
    s_waitcnt lgkmcnt(5)
    v_add_f32 v32, v32, v40
    v_add_f32 v33, v33, v41
    v_add_f32 v34, v34, v42
    buffer_load_dwordx4 v6, s[44:47], s91 offen offset:1024 sc1 lds
    s_waitcnt lgkmcnt(3)
    v_mfma_f32_32x32x16_bf16 v[16:31], v[124:127], v[48:51], v[16:31]
    ds_read_b128 v[56:59], v2 offset:4096
    v_add_f32 v35, v35, v43
    v_add_f32 v36, v36, v44
    v_add_f32 v37, v37, v45
    v_add_f32 v38, v38, v46
    s_waitcnt lgkmcnt(3)
    v_mfma_f32_32x32x16_bf16 v[16:31], v[128:131], v[52:55], v[16:31]
    ds_read_b128 v[48:51], v3 offset:4096
    v_add_f32 v39, v39, v47
    s_waitcnt lgkmcnt(3)
    v_lshlrev_b32 v68, 16, v64
    v_and_b32 v69, 0xffff0000, v64
    s_waitcnt lgkmcnt(2)
    v_mfma_f32_32x32x16_bf16 v[16:31], v[132:135], v[60:63], v[16:31]
    ds_read_b128 v[52:55], v4 offset:4096
    v_lshlrev_b32 v70, 16, v65
    v_and_b32 v71, 0xffff0000, v65
    v_fma_f32 v32, v32, s101, v68
    v_fma_f32 v33, v33, s101, v69
    s_waitcnt lgkmcnt(2)
    v_mfma_f32_32x32x16_bf16 v[16:31], v[136:139], v[56:59], v[16:31]
    ds_read_b128 v[60:63], v5 offset:4096
    v_fma_f32 v34, v34, s101, v70
    v_fma_f32 v35, v35, s101, v71
    v_cvt_pk_bf16_f32 v64, v32, v33
    v_cvt_pk_bf16_f32 v65, v34, v35
    s_waitcnt lgkmcnt(2)
    v_mfma_f32_32x32x16_bf16 v[16:31], v[140:143], v[48:51], v[16:31]
    ds_read_b128 v[56:59], v2 offset:5120
    v_lshlrev_b32 v68, 16, v66
    v_and_b32 v69, 0xffff0000, v66
    v_lshlrev_b32 v70, 16, v67
    s_waitcnt lgkmcnt(2)
    v_mfma_f32_32x32x16_bf16 v[16:31], v[144:147], v[52:55], v[16:31]
    ds_read_b128 v[48:51], v3 offset:5120
    v_and_b32 v71, 0xffff0000, v67
    v_fma_f32 v36, v36, s101, v68
    v_fma_f32 v37, v37, s101, v69
    v_fma_f32 v38, v38, s101, v70
    s_waitcnt lgkmcnt(2)
    v_mfma_f32_32x32x16_bf16 v[16:31], v[148:151], v[60:63], v[16:31]
    ds_read_b128 v[52:55], v4 offset:5120
    v_fma_f32 v39, v39, s101, v71
    v_cvt_pk_bf16_f32 v66, v36, v37
    v_cvt_pk_bf16_f32 v67, v38, v39
    s_waitcnt lgkmcnt(2)
    v_mfma_f32_32x32x16_bf16 v[16:31], v[152:155], v[56:59], v[16:31]
    ds_read_b128 v[60:63], v5 offset:5120
    s_mov_b32 exec_hi, 0xff
    buffer_store_dwordx4 v[64:67], v1, s[56:59], s80 offen sc1
    buffer_store_dwordx4 v[64:67], v13, s[40:43], s80 offen
    s_mov_b32 exec_hi, -1
    s_waitcnt lgkmcnt(2)
    v_mfma_f32_32x32x16_bf16 v[16:31], v[156:159], v[48:51], v[16:31]
    ds_read_b128 v[56:59], v2 offset:6144
    s_waitcnt lgkmcnt(2)
    v_mfma_f32_32x32x16_bf16 v[16:31], v[160:163], v[52:55], v[16:31]
    ds_read_b128 v[48:51], v3 offset:6144
    s_waitcnt lgkmcnt(2)
    v_mfma_f32_32x32x16_bf16 v[16:31], v[164:167], v[60:63], v[16:31]
    ds_read_b128 v[52:55], v4 offset:6144
    s_waitcnt lgkmcnt(2)
    v_mfma_f32_32x32x16_bf16 v[16:31], v[168:171], v[56:59], v[16:31]
    ds_read_b128 v[60:63], v5 offset:6144
    s_waitcnt lgkmcnt(2)
    v_mfma_f32_32x32x16_bf16 v[16:31], v[172:175], v[48:51], v[16:31]
    ds_read_b128 v[56:59], v2 offset:7168
    s_waitcnt lgkmcnt(2)
    v_mfma_f32_32x32x16_bf16 v[16:31], v[176:179], v[52:55], v[16:31]
    ds_read_b128 v[48:51], v3 offset:7168
    s_waitcnt lgkmcnt(2)
    v_mfma_f32_32x32x16_bf16 v[16:31], v[180:183], v[60:63], v[16:31]
    ds_read_b128 v[52:55], v4 offset:7168
    s_waitcnt lgkmcnt(2)
    v_mfma_f32_32x32x16_bf16 v[16:31], v[184:187], v[56:59], v[16:31]
    ds_read_b128 v[60:63], v5 offset:7168
    buffer_load_dword v14, v9, s[44:47], s73 offen sc1
    s_add_u32 s80, s80, 655360
    s_add_u32 s76, s76, 114688
    s_waitcnt lgkmcnt(2)
    v_mfma_f32_32x32x16_bf16 v[16:31], v[188:191], v[48:51], v[16:31]
    ds_read_b128 v[56:59], v2 offset:8192
    s_waitcnt lgkmcnt(2)
    v_mfma_f32_32x32x16_bf16 v[16:31], v[192:195], v[52:55], v[16:31]
    ds_read_b128 v[48:51], v3 offset:8192
    s_add_u32 s77, s77, 16384
    s_min_u32 s77, s77, 577536
    s_waitcnt lgkmcnt(2)
    v_mfma_f32_32x32x16_bf16 v[16:31], v[196:199], v[60:63], v[16:31]
    ds_read_b128 v[52:55], v4 offset:8192
    s_add_u32 s79, s79, 655360
    s_add_u32 s70, s70, 655360
    s_waitcnt lgkmcnt(2)
    v_mfma_f32_32x32x16_bf16 v[16:31], v[200:203], v[56:59], v[16:31]
    ds_read_b128 v[60:63], v5 offset:8192
    s_add_u32 s78, s78, 655360
    s_add_u32 s75, s75, s34
    s_waitcnt lgkmcnt(2)
    v_mfma_f32_32x32x16_bf16 v[16:31], v[204:207], v[48:51], v[16:31]
    ds_read_b128 v[56:59], v2 offset:9216
    s_cmp_ge_u32 s68, 5
    s_cselect_b32 s10, 41943040, 0
    s_waitcnt lgkmcnt(2)
    v_mfma_f32_32x32x16_bf16 v[16:31], v[208:211], v[52:55], v[16:31]
    ds_read_b128 v[48:51], v3 offset:9216
    s_waitcnt lgkmcnt(2)
    v_mfma_f32_32x32x16_bf16 v[16:31], v[212:215], v[60:63], v[16:31]
    ds_read_b128 v[52:55], v4 offset:9216
    s_waitcnt lgkmcnt(2)
    v_mfma_f32_32x32x16_bf16 v[16:31], v[216:219], v[56:59], v[16:31]
    ds_read_b128 v[60:63], v5 offset:9216
    s_waitcnt vmcnt(3)
    s_barrier
    s_waitcnt lgkmcnt(2)
    v_mfma_f32_32x32x16_bf16 v[16:31], v[220:223], v[48:51], v[16:31]
    ds_read_b128 v[56:59], v2 offset:40960
    s_waitcnt lgkmcnt(2)
    v_mfma_f32_32x32x16_bf16 v[16:31], v[224:227], v[52:55], v[16:31]
    ds_read_b128 v[48:51], v3 offset:40960
    s_waitcnt lgkmcnt(2)
    v_mfma_f32_32x32x16_bf16 v[16:31], v[228:231], v[60:63], v[16:31]
    ds_read_b128 v[52:55], v4 offset:40960
    s_waitcnt lgkmcnt(2)
    v_mfma_f32_32x32x16_bf16 v[32:47], v[72:75], v[56:59], 0
    ds_read_b128 v[60:63], v5 offset:40960
    s_waitcnt lgkmcnt(2)
    v_mfma_f32_32x32x16_bf16 v[32:47], v[76:79], v[48:51], v[32:47]
    ds_read_b128 v[56:59], v2 offset:41984
    v_fma_f32 v68, v16, v16, s100
    v_fma_f32 v69, v17, v17, s100
    v_fma_f32 v70, v18, v18, s100
    s_waitcnt lgkmcnt(2)
    v_mfma_f32_32x32x16_bf16 v[32:47], v[80:83], v[52:55], v[32:47]
    ds_read_b128 v[48:51], v3 offset:41984
    v_fma_f32 v71, v19, v19, s100
    v_mul_f32 v24, v24, v16
    s_waitcnt lgkmcnt(2)
    v_mfma_f32_32x32x16_bf16 v[32:47], v[84:87], v[60:63], v[32:47]
    ds_read_b128 v[52:55], v4 offset:41984
    v_mul_f32 v25, v25, v17
    v_mul_f32 v26, v26, v18
    s_waitcnt lgkmcnt(2)
    v_mfma_f32_32x32x16_bf16 v[32:47], v[88:91], v[56:59], v[32:47]
    ds_read_b128 v[60:63], v5 offset:41984
    v_mul_f32 v27, v27, v19
    v_mul_f32 v16, v16, v68
    s_waitcnt lgkmcnt(2)
    v_mfma_f32_32x32x16_bf16 v[32:47], v[92:95], v[48:51], v[32:47]
    ds_read_b128 v[56:59], v2 offset:43008
    v_mul_f32 v17, v17, v69
    v_mul_f32 v18, v18, v70
    s_waitcnt lgkmcnt(2)
    v_mfma_f32_32x32x16_bf16 v[32:47], v[96:99], v[52:55], v[32:47]
    ds_read_b128 v[48:51], v3 offset:43008
    v_mul_f32 v19, v19, v71
    v_exp_f32 v16, -v16
    s_waitcnt lgkmcnt(2)
    v_mfma_f32_32x32x16_bf16 v[32:47], v[100:103], v[60:63], v[32:47]
    ds_read_b128 v[52:55], v4 offset:43008
    v_exp_f32 v17, -v17
    v_exp_f32 v18, -v18
    s_waitcnt lgkmcnt(2)
    v_mfma_f32_32x32x16_bf16 v[32:47], v[104:107], v[56:59], v[32:47]
    ds_read_b128 v[60:63], v5 offset:43008
    s_waitcnt vmcnt(0)
    v_cmp_ne_u32 vcc, s48, v14
    s_cbranch_vccnz SPIN_14
SRET_15:
    v_exp_f32 v19, -v19
    v_add_f32 v16, 1.0, v16
    v_add_f32 v17, 1.0, v17
    s_waitcnt lgkmcnt(2)
    v_mfma_f32_32x32x16_bf16 v[32:47], v[108:111], v[48:51], v[32:47]
    ds_read_b128 v[56:59], v2 offset:44032
    s_mov_b32 m0, s83
    s_nop 0
    buffer_load_dwordx4 v1, s[44:47], s75 offen offset:0 sc1 lds
    v_add_f32 v18, 1.0, v18
    v_add_f32 v19, 1.0, v19
    s_waitcnt lgkmcnt(2)
    v_mfma_f32_32x32x16_bf16 v[32:47], v[112:115], v[52:55], v[32:47]
    ds_read_b128 v[48:51], v3 offset:44032
    v_rcp_f32 v16, v16
    v_rcp_f32 v17, v17
    s_waitcnt lgkmcnt(2)
    v_mfma_f32_32x32x16_bf16 v[32:47], v[116:119], v[60:63], v[32:47]
    ds_read_b128 v[52:55], v4 offset:44032
    buffer_load_dwordx4 v1, s[44:47], s75 offen offset:1024 sc1 lds
    v_rcp_f32 v18, v18
    v_rcp_f32 v19, v19
    s_waitcnt lgkmcnt(2)
    v_mfma_f32_32x32x16_bf16 v[32:47], v[120:123], v[56:59], v[32:47]
    ds_read_b128 v[60:63], v5 offset:44032
    v_mul_f32 v24, v24, v16
    v_mul_f32 v25, v25, v17
    s_waitcnt lgkmcnt(2)
    v_mfma_f32_32x32x16_bf16 v[32:47], v[124:127], v[48:51], v[32:47]
    ds_read_b128 v[56:59], v2 offset:45056
    buffer_load_dwordx4 v1, s[44:47], s75 offen offset:2048 sc1 lds
    v_mul_f32 v26, v26, v18
    v_mul_f32 v27, v27, v19
    s_waitcnt lgkmcnt(2)
    v_mfma_f32_32x32x16_bf16 v[32:47], v[128:131], v[52:55], v[32:47]
    ds_read_b128 v[48:51], v3 offset:45056
    v_cvt_pk_bf16_f32 v64, v24, v25
    v_cvt_pk_bf16_f32 v65, v26, v27
    s_waitcnt lgkmcnt(2)
    v_mfma_f32_32x32x16_bf16 v[32:47], v[132:135], v[60:63], v[32:47]
    ds_read_b128 v[52:55], v4 offset:45056
    buffer_load_dwordx4 v1, s[44:47], s75 offen offset:3072 sc1 lds
    v_fma_f32 v68, v20, v20, s100
    v_fma_f32 v69, v21, v21, s100
    v_fma_f32 v70, v22, v22, s100
    s_waitcnt lgkmcnt(2)
    v_mfma_f32_32x32x16_bf16 v[32:47], v[136:139], v[56:59], v[32:47]
    ds_read_b128 v[60:63], v5 offset:45056
    v_fma_f32 v71, v23, v23, s100
    v_mul_f32 v28, v28, v20
    s_waitcnt lgkmcnt(2)
    v_mfma_f32_32x32x16_bf16 v[32:47], v[140:143], v[48:51], v[32:47]
    ds_read_b128 v[56:59], v2 offset:46080
    s_add_u32 m0, m0, 4096
    s_add_u32 s75, s75, 4096
    buffer_load_dwordx4 v1, s[44:47], s75 offen offset:0 sc1 lds
    v_mul_f32 v29, v29, v21
    v_mul_f32 v30, v30, v22
    s_waitcnt lgkmcnt(2)
    v_mfma_f32_32x32x16_bf16 v[32:47], v[144:147], v[52:55], v[32:47]
    ds_read_b128 v[48:51], v3 offset:46080
    v_mul_f32 v31, v31, v23
    v_mul_f32 v20, v20, v68
    s_waitcnt lgkmcnt(2)
    v_mfma_f32_32x32x16_bf16 v[32:47], v[148:151], v[60:63], v[32:47]
    ds_read_b128 v[52:55], v4 offset:46080
    buffer_load_dwordx4 v1, s[44:47], s75 offen offset:1024 sc1 lds
    v_mul_f32 v21, v21, v69
    v_mul_f32 v22, v22, v70
    s_waitcnt lgkmcnt(2)
    v_mfma_f32_32x32x16_bf16 v[32:47], v[152:155], v[56:59], v[32:47]
    ds_read_b128 v[60:63], v5 offset:46080
    v_mul_f32 v23, v23, v71
    v_exp_f32 v20, -v20
    s_waitcnt lgkmcnt(2)
    v_mfma_f32_32x32x16_bf16 v[32:47], v[156:159], v[48:51], v[32:47]
    ds_read_b128 v[56:59], v2 offset:47104
    buffer_load_dwordx4 v1, s[44:47], s75 offen offset:2048 sc1 lds
    v_exp_f32 v21, -v21
    v_exp_f32 v22, -v22
    s_waitcnt lgkmcnt(2)
    v_mfma_f32_32x32x16_bf16 v[32:47], v[160:163], v[52:55], v[32:47]
    ds_read_b128 v[48:51], v3 offset:47104
    v_exp_f32 v23, -v23
    v_add_f32 v20, 1.0, v20
    v_add_f32 v21, 1.0, v21
    s_waitcnt lgkmcnt(2)
    v_mfma_f32_32x32x16_bf16 v[32:47], v[164:167], v[60:63], v[32:47]
    ds_read_b128 v[52:55], v4 offset:47104
    buffer_load_dwordx4 v1, s[44:47], s75 offen offset:3072 sc1 lds
    v_add_f32 v22, 1.0, v22
    v_add_f32 v23, 1.0, v23
    s_waitcnt lgkmcnt(2)
    v_mfma_f32_32x32x16_bf16 v[32:47], v[168:171], v[56:59], v[32:47]
    ds_read_b128 v[60:63], v5 offset:47104
    buffer_load_dword v14, v10, s[44:47], s77 offen sc1
    v_rcp_f32 v20, v20
    v_rcp_f32 v21, v21
    s_waitcnt lgkmcnt(2)
    v_mfma_f32_32x32x16_bf16 v[32:47], v[172:175], v[48:51], v[32:47]
    ds_read_b128 v[56:59], v2 offset:48128
    s_add_u32 m0, m0, 4096
    s_add_u32 s75, s75, 4096
    buffer_load_dwordx4 v1, s[44:47], s75 offen offset:0 sc1 lds
    v_rcp_f32 v22, v22
    v_rcp_f32 v23, v23
    s_waitcnt lgkmcnt(2)
    v_mfma_f32_32x32x16_bf16 v[32:47], v[176:179], v[52:55], v[32:47]
    ds_read_b128 v[48:51], v3 offset:48128
    v_mul_f32 v28, v28, v20
    v_mul_f32 v29, v29, v21
    s_waitcnt lgkmcnt(2)
    v_mfma_f32_32x32x16_bf16 v[32:47], v[180:183], v[60:63], v[32:47]
    ds_read_b128 v[52:55], v4 offset:48128
    buffer_load_dwordx4 v1, s[44:47], s75 offen offset:1024 sc1 lds
    v_mul_f32 v30, v30, v22
    v_mul_f32 v31, v31, v23
    s_waitcnt lgkmcnt(2)
    v_mfma_f32_32x32x16_bf16 v[32:47], v[184:187], v[56:59], v[32:47]
    ds_read_b128 v[60:63], v5 offset:48128
    v_cvt_pk_bf16_f32 v66, v28, v29
    v_cvt_pk_bf16_f32 v67, v30, v31
    s_waitcnt lgkmcnt(2)
    v_mfma_f32_32x32x16_bf16 v[32:47], v[188:191], v[48:51], v[32:47]
    ds_read_b128 v[56:59], v2 offset:49152
    buffer_load_dwordx4 v1, s[44:47], s75 offen offset:2048 sc1 lds
    s_waitcnt lgkmcnt(2)
    v_mfma_f32_32x32x16_bf16 v[32:47], v[192:195], v[52:55], v[32:47]
    ds_read_b128 v[48:51], v3 offset:49152
    buffer_store_dwordx4 v[64:67], v8, s[44:47], s71 offen sc1
    s_add_u32 s71, s71, 114688
    s_waitcnt lgkmcnt(2)
    v_mfma_f32_32x32x16_bf16 v[32:47], v[196:199], v[60:63], v[32:47]
    ds_read_b128 v[52:55], v4 offset:49152
    buffer_load_dwordx4 v1, s[44:47], s75 offen offset:3072 sc1 lds
    s_waitcnt lgkmcnt(2)
    v_mfma_f32_32x32x16_bf16 v[32:47], v[200:203], v[56:59], v[32:47]
    ds_read_b128 v[60:63], v5 offset:49152
    s_waitcnt lgkmcnt(2)
    v_mfma_f32_32x32x16_bf16 v[32:47], v[204:207], v[48:51], v[32:47]
    ds_read_b128 v[56:59], v2 offset:50176
    s_add_u32 m0, m0, 4096
    s_add_u32 s75, s75, s33
    buffer_load_dwordx4 v1, s[44:47], s75 offen offset:0 sc1 lds
    s_waitcnt lgkmcnt(2)
    v_mfma_f32_32x32x16_bf16 v[32:47], v[208:211], v[52:55], v[32:47]
    ds_read_b128 v[48:51], v3 offset:50176
    s_waitcnt lgkmcnt(2)
    v_mfma_f32_32x32x16_bf16 v[32:47], v[212:215], v[60:63], v[32:47]
    ds_read_b128 v[52:55], v4 offset:50176
    buffer_load_dwordx4 v1, s[44:47], s75 offen offset:1024 sc1 lds
    s_waitcnt lgkmcnt(2)
    v_mfma_f32_32x32x16_bf16 v[32:47], v[216:219], v[56:59], v[32:47]
    ds_read_b128 v[60:63], v5 offset:50176
    s_waitcnt vmcnt(7)
    v_cmp_ne_u32 vcc, s48, v14
    s_cmp_eq_u64 vcc, 0
    s_cselect_b32 s62, 41943040, 0
    s_cmp_eq_u32 s68, 7
    s_cselect_b32 s62, 0, s62
    s_waitcnt lgkmcnt(2)
    v_mfma_f32_32x32x16_bf16 v[32:47], v[220:223], v[48:51], v[32:47]
    s_add_u32 m0, s83, 14336
    s_mov_b32 exec_hi, 0xff
    buffer_load_dwordx4 v1, s[8:11], s78 offen sc1 lds
    s_mov_b32 exec_hi, -1
    s_add_u32 m0, s82, 0
    s_nop 0
    buffer_load_dwordx4 v1, s[60:63], s79 offen offset:0 sc1 lds
    s_waitcnt lgkmcnt(1)
    v_mfma_f32_32x32x16_bf16 v[32:47], v[224:227], v[52:55], v[32:47]
    ds_read_b128 v[48:51], v7 offset:0
    s_waitcnt lgkmcnt(1)
    v_mfma_f32_32x32x16_bf16 v[32:47], v[228:231], v[60:63], v[32:47]
    buffer_load_dwordx4 v1, s[60:63], s79 offen offset:1024 sc1 lds
    ds_read_b128 v[52:55], v7 offset:1024
    s_waitcnt lgkmcnt(1)
    v_mfma_f32_16x16x32_bf16 v[16:19], v[232:235], v[48:51], 0
    ds_read_b128 v[56:59], v7 offset:2048
    v_mfma_f32_16x16x32_bf16 v[20:23], v[236:239], v[48:51], 0
    s_nop 1
    v_pk_fma_f32 v[64:65], v[32:33], v[32:33], s[100:101] op_sel_hi:[1,1,0]
    v_pk_fma_f32 v[66:67], v[34:35], v[34:35], s[100:101] op_sel_hi:[1,1,0]
    v_pk_fma_f32 v[68:69], v[36:37], v[36:37], s[100:101] op_sel_hi:[1,1,0]
    v_pk_fma_f32 v[70:71], v[38:39], v[38:39], s[100:101] op_sel_hi:[1,1,0]
    v_pk_mul_f32 v[40:41], v[32:33], v[40:41]
    v_pk_mul_f32 v[42:43], v[34:35], v[42:43]
    v_pk_mul_f32 v[44:45], v[36:37], v[44:45]
    v_pk_mul_f32 v[46:47], v[38:39], v[46:47]
    v_pk_mul_f32 v[32:33], v[32:33], v[64:65]
    v_pk_mul_f32 v[34:35], v[34:35], v[66:67]
    v_pk_mul_f32 v[36:37], v[36:37], v[68:69]
    v_pk_mul_f32 v[38:39], v[38:39], v[70:71]
    v_mfma_f32_16x16x32_bf16 v[24:27], v[240:243], v[48:51], 0
    v_exp_f32 v32, -v32
    v_exp_f32 v33, -v33
    v_mfma_f32_16x16x32_bf16 v[28:31], v[244:247], v[48:51], 0
    v_exp_f32 v34, -v34
    buffer_load_dwordx4 v1, s[60:63], s79 offen offset:2048 sc1 lds
    v_mfma_f32_16x16x32_bf16 v[60:63], v[248:251], v[48:51], 0
    v_exp_f32 v35, -v35
    s_waitcnt lgkmcnt(1)
    v_mfma_f32_16x16x32_bf16 v[16:19], v[252:255], v[52:55], v[16:19]
    ds_read_b128 v[48:51], v7 offset:3072
    v_exp_f32 v36, -v36
    v_exp_f32 v37, -v37
    v_mfma_f32_16x16x32_bf16 v[20:23], a[0:3], v[52:55], v[20:23]
    v_exp_f32 v38, -v38
    v_mfma_f32_16x16x32_bf16 v[24:27], a[32:35], v[52:55], v[24:27]
    v_exp_f32 v39, -v39
    v_mfma_f32_16x16x32_bf16 v[28:31], a[64:67], v[52:55], v[28:31]
    v_pk_add_f32 v[32:33], v[32:33], 1.0 op_sel_hi:[1,0]
    v_pk_add_f32 v[34:35], v[34:35], 1.0 op_sel_hi:[1,0]
    v_pk_add_f32 v[36:37], v[36:37], 1.0 op_sel_hi:[1,0]
    v_pk_add_f32 v[38:39], v[38:39], 1.0 op_sel_hi:[1,0]
    buffer_load_dwordx4 v1, s[60:63], s79 offen offset:3072 sc1 lds
    v_mfma_f32_16x16x32_bf16 v[60:63], a[96:99], v[52:55], v[60:63]
    v_rcp_f32 v32, v32
    v_rcp_f32 v33, v33
    s_waitcnt lgkmcnt(1)
    v_mfma_f32_16x16x32_bf16 v[16:19], a[156:159], v[56:59], v[16:19]
    s_waitcnt vmcnt(11)
    ds_read_b128 v[52:55], v7 offset:4096
    v_rcp_f32 v34, v34
    v_mfma_f32_16x16x32_bf16 v[20:23], a[188:191], v[56:59], v[20:23]
    v_rcp_f32 v35, v35
    v_mfma_f32_16x16x32_bf16 v[24:27], a[220:223], v[56:59], v[24:27]
    v_rcp_f32 v36, v36
    v_rcp_f32 v37, v37
    v_mfma_f32_16x16x32_bf16 v[28:31], a[252:255], v[56:59], v[28:31]
    v_rcp_f32 v38, v38
    s_add_u32 m0, m0, 4096
    s_nop 0
    buffer_load_dwordx4 v6, s[60:63], s79 offen offset:0 sc1 lds
    v_mfma_f32_16x16x32_bf16 v[60:63], a[4:7], v[56:59], v[60:63]
    v_rcp_f32 v39, v39
    s_waitcnt lgkmcnt(1)
    v_mfma_f32_16x16x32_bf16 v[16:19], a[36:39], v[48:51], v[16:19]
    ds_read_b128 v[56:59], v7 offset:5120
    v_pk_mul_f32 v[40:41], v[40:41], v[32:33]
    v_pk_mul_f32 v[42:43], v[42:43], v[34:35]
    v_pk_mul_f32 v[44:45], v[44:45], v[36:37]
    v_pk_mul_f32 v[46:47], v[46:47], v[38:39]
    v_mfma_f32_16x16x32_bf16 v[20:23], a[68:71], v[48:51], v[20:23]
    v_cvt_pk_bf16_f32 v64, v40, v41
    v_cvt_pk_bf16_f32 v65, v42, v43
    v_mfma_f32_16x16x32_bf16 v[24:27], a[100:103], v[48:51], v[24:27]
    v_cvt_pk_bf16_f32 v66, v44, v45
    v_cvt_pk_bf16_f32 v67, v46, v47
    v_mfma_f32_16x16x32_bf16 v[28:31], a[152:155], v[48:51], v[28:31]
    buffer_store_dwordx4 v[64:67], v8, s[44:47], s71 offen sc1
    s_add_u32 s71, s71, 1720320
    buffer_load_dwordx4 v6, s[60:63], s79 offen offset:1024 sc1 lds
    v_mfma_f32_16x16x32_bf16 v[60:63], a[184:187], v[48:51], v[60:63]
    s_waitcnt lgkmcnt(1)
    v_mfma_f32_16x16x32_bf16 v[16:19], a[216:219], v[52:55], v[16:19]
    ds_read_b128 v[48:51], v7 offset:6144
    v_mfma_f32_16x16x32_bf16 v[20:23], a[248:251], v[52:55], v[20:23]
    v_mfma_f32_16x16x32_bf16 v[24:27], a[8:11], v[52:55], v[24:27]
    v_mfma_f32_16x16x32_bf16 v[28:31], a[40:43], v[52:55], v[28:31]
    buffer_load_dwordx4 v6, s[60:63], s79 offen offset:2048 sc1 lds
    v_mfma_f32_16x16x32_bf16 v[60:63], a[72:75], v[52:55], v[60:63]
    s_waitcnt lgkmcnt(1)
    v_mfma_f32_16x16x32_bf16 v[16:19], a[104:107], v[56:59], v[16:19]
    ds_read_b128 v[52:55], v7 offset:7168
    v_mfma_f32_16x16x32_bf16 v[20:23], a[148:151], v[56:59], v[20:23]
    v_mfma_f32_16x16x32_bf16 v[24:27], a[180:183], v[56:59], v[24:27]
    v_mfma_f32_16x16x32_bf16 v[28:31], a[212:215], v[56:59], v[28:31]
    buffer_load_dwordx4 v6, s[60:63], s79 offen offset:3072 sc1 lds
    v_mfma_f32_16x16x32_bf16 v[60:63], a[244:247], v[56:59], v[60:63]
    s_waitcnt lgkmcnt(1)
    v_mfma_f32_16x16x32_bf16 v[16:19], a[12:15], v[48:51], v[16:19]
    ds_read_b128 v[56:59], v7 offset:8192
    v_mfma_f32_16x16x32_bf16 v[20:23], a[44:47], v[48:51], v[20:23]
    v_mfma_f32_16x16x32_bf16 v[24:27], a[76:79], v[48:51], v[24:27]
    v_mfma_f32_16x16x32_bf16 v[28:31], a[108:111], v[48:51], v[28:31]
    s_add_u32 m0, m0, 4096
    s_add_u32 s91, s79, 4096
    buffer_load_dwordx4 v6, s[60:63], s91 offen offset:0 sc1 lds
    v_mfma_f32_16x16x32_bf16 v[60:63], a[144:147], v[48:51], v[60:63]
    s_waitcnt lgkmcnt(1)
    v_mfma_f32_16x16x32_bf16 v[16:19], a[176:179], v[52:55], v[16:19]
    s_waitcnt vmcnt(11)
    ds_read_b128 v[48:51], v7 offset:9216
    v_mfma_f32_16x16x32_bf16 v[20:23], a[208:211], v[52:55], v[20:23]
    s_mov_b64 exec, 1
    buffer_store_dword v15, off, s[44:47], s76 sc1
    s_mov_b64 exec, -1
    v_mfma_f32_16x16x32_bf16 v[24:27], a[240:243], v[52:55], v[24:27]
    v_mfma_f32_16x16x32_bf16 v[28:31], a[16:19], v[52:55], v[28:31]
    buffer_load_dwordx4 v6, s[60:63], s91 offen offset:1024 sc1 lds
    v_mfma_f32_16x16x32_bf16 v[60:63], a[48:51], v[52:55], v[60:63]
    s_waitcnt lgkmcnt(1)
    v_mfma_f32_16x16x32_bf16 v[16:19], a[80:83], v[56:59], v[16:19]
    ds_read_b128 v[52:55], v7 offset:10240
    v_mfma_f32_16x16x32_bf16 v[20:23], a[112:115], v[56:59], v[20:23]
    v_mfma_f32_16x16x32_bf16 v[24:27], a[140:143], v[56:59], v[24:27]
    v_mfma_f32_16x16x32_bf16 v[28:31], a[172:175], v[56:59], v[28:31]
    v_mfma_f32_16x16x32_bf16 v[60:63], a[204:207], v[56:59], v[60:63]
    s_waitcnt lgkmcnt(1)
    v_mfma_f32_16x16x32_bf16 v[16:19], a[236:239], v[48:51], v[16:19]
    ds_read_b128 v[56:59], v7 offset:11264
    v_mfma_f32_16x16x32_bf16 v[20:23], a[24:27], v[48:51], v[20:23]
    v_mfma_f32_16x16x32_bf16 v[24:27], a[56:59], v[48:51], v[24:27]
    v_mfma_f32_16x16x32_bf16 v[28:31], a[88:91], v[48:51], v[28:31]
    v_mfma_f32_16x16x32_bf16 v[60:63], a[120:123], v[48:51], v[60:63]
    s_waitcnt lgkmcnt(1)
    v_mfma_f32_16x16x32_bf16 v[16:19], a[132:135], v[52:55], v[16:19]
    ds_read_b128 v[48:51], v7 offset:12288
    v_mfma_f32_16x16x32_bf16 v[20:23], a[164:167], v[52:55], v[20:23]
    v_mfma_f32_16x16x32_bf16 v[24:27], a[196:199], v[52:55], v[24:27]
    v_mfma_f32_16x16x32_bf16 v[28:31], a[228:231], v[52:55], v[28:31]
    v_mfma_f32_16x16x32_bf16 v[60:63], a[20:23], v[52:55], v[60:63]
    s_waitcnt lgkmcnt(1)
    v_mfma_f32_16x16x32_bf16 v[16:19], a[52:55], v[56:59], v[16:19]
    ds_read_b128 v[52:55], v7 offset:13312
    v_mfma_f32_16x16x32_bf16 v[20:23], a[84:87], v[56:59], v[20:23]
    v_mfma_f32_16x16x32_bf16 v[24:27], a[116:119], v[56:59], v[24:27]
    v_mfma_f32_16x16x32_bf16 v[28:31], a[136:139], v[56:59], v[28:31]
    v_mfma_f32_16x16x32_bf16 v[60:63], a[168:171], v[56:59], v[60:63]
    s_waitcnt lgkmcnt(1)
    v_mfma_f32_16x16x32_bf16 v[16:19], a[200:203], v[48:51], v[16:19]
    s_cmp_lg_u32 s62, 0
    s_cbranch_scc1 ONTIME_16
    s_cmp_eq_u32 s68, 7
    s_cbranch_scc1 ONTIME_16
    s_call_b64 s[92:93], A_LATE
ONTIME_16:
    s_waitcnt vmcnt(10)
    s_barrier
    ds_read_b128 v[56:59], v2 offset:0
    v_mfma_f32_16x16x32_bf16 v[20:23], a[232:235], v[48:51], v[20:23]
    v_mfma_f32_16x16x32_bf16 v[24:27], a[28:31], v[48:51], v[24:27]
    s_add_u32 s68, s68, 1
    v_mfma_f32_16x16x32_bf16 v[28:31], a[60:63], v[48:51], v[28:31]
    s_add_u32 s73, s73, 114688
    v_mfma_f32_16x16x32_bf16 v[60:63], a[92:95], v[48:51], v[60:63]
    ds_read_b128 v[48:51], v3 offset:0
    s_waitcnt lgkmcnt(2)
    v_mfma_f32_16x16x32_bf16 v[16:19], a[124:127], v[52:55], v[16:19]
    v_mfma_f32_16x16x32_bf16 v[20:23], a[128:131], v[52:55], v[20:23]
    v_mfma_f32_16x16x32_bf16 v[24:27], a[160:163], v[52:55], v[24:27]
    s_nop 1
    ds_write_b128 v11, v[16:19] offset:0
    v_mfma_f32_16x16x32_bf16 v[28:31], a[192:195], v[52:55], v[28:31]
    s_nop 0
    ds_write_b128 v11, v[20:23] offset:64
    v_mfma_f32_16x16x32_bf16 v[60:63], a[224:227], v[52:55], v[60:63]
    s_nop 0
    ds_write_b128 v11, v[24:27] offset:128
    s_nop 2
    ds_write_b128 v11, v[28:31] offset:192
    s_cmp_lt_u32 s68, 8
    s_cbranch_scc1 G1_LOOP
    ds_write_b128 v11, v[60:63] offset:256
    s_waitcnt lgkmcnt(0)
    s_barrier
    ds_read_b128 v[32:35], v12 offset:0
    ds_read_b128 v[40:43], v12 offset:5376
    ds_read_b128 v[36:39], v12 offset:16
    ds_read_b128 v[44:47], v12 offset:5392
    ds_read_b128 v[64:67], v12 offset:10752
    ds_read_b128 v[68:71], v12 offset:10768
    s_waitcnt vmcnt(6)
    s_mov_b64 exec, 1
    buffer_store_dword v15, off, s[44:47], s76 offset:64 sc1
    s_mov_b64 exec, -1
    s_waitcnt lgkmcnt(4)
    v_pk_add_f32 v[32:33], v[32:33], v[40:41]
    v_pk_add_f32 v[34:35], v[34:35], v[42:43]
    s_waitcnt lgkmcnt(2)
    v_pk_add_f32 v[36:37], v[36:37], v[44:45]
    v_pk_add_f32 v[38:39], v[38:39], v[46:47]
    ds_read_b128 v[40:43], v12 offset:16128
    ds_read_b128 v[44:47], v12 offset:16144
    s_waitcnt lgkmcnt(3)
    v_pk_add_f32 v[32:33], v[32:33], v[64:65]
    v_pk_add_f32 v[34:35], v[34:35], v[66:67]
    s_waitcnt lgkmcnt(2)
    v_pk_add_f32 v[36:37], v[36:37], v[68:69]
    v_pk_add_f32 v[38:39], v[38:39], v[70:71]
    ds_read_b128 v[64:67], v7 offset:14336
    s_waitcnt lgkmcnt(2)
    v_pk_add_f32 v[32:33], v[32:33], v[40:41]
    v_pk_add_f32 v[34:35], v[34:35], v[42:43]
    s_waitcnt lgkmcnt(1)
    v_pk_add_f32 v[36:37], v[36:37], v[44:45]
    v_pk_add_f32 v[38:39], v[38:39], v[46:47]
    s_waitcnt lgkmcnt(0)
    v_lshlrev_b32 v68, 16, v64
    v_and_b32 v69, 0xffff0000, v64
    v_lshlrev_b32 v70, 16, v65
    v_and_b32 v71, 0xffff0000, v65
    v_pk_fma_f32 v[32:33], v[32:33], s[100:101], v[68:69] op_sel:[0,1,0] op_sel_hi:[1,1,1]
    v_pk_fma_f32 v[34:35], v[34:35], s[100:101], v[70:71] op_sel:[0,1,0] op_sel_hi:[1,1,1]
    v_cvt_pk_bf16_f32 v64, v32, v33
    v_cvt_pk_bf16_f32 v65, v34, v35
    v_lshlrev_b32 v68, 16, v66
    v_and_b32 v69, 0xffff0000, v66
    v_lshlrev_b32 v70, 16, v67
    v_and_b32 v71, 0xffff0000, v67
    v_pk_fma_f32 v[36:37], v[36:37], s[100:101], v[68:69] op_sel:[0,1,0] op_sel_hi:[1,1,1]
    v_pk_fma_f32 v[38:39], v[38:39], s[100:101], v[70:71] op_sel:[0,1,0] op_sel_hi:[1,1,1]
    v_cvt_pk_bf16_f32 v66, v36, v37
    v_cvt_pk_bf16_f32 v67, v38, v39
    s_mov_b32 exec_hi, 0xff
    buffer_store_dwordx4 v[64:67], v1, s[56:59], s80 offen sc1
    buffer_store_dwordx4 v[64:67], v13, s[40:43], s80 offen
    s_mov_b32 exec_hi, -1
    s_mov_b32 s74, 7
    s_call_b64 s[92:93], G_SUB
DONE:
    s_or_b32 s86, s2, s49
    s_cbranch_scc1 FIN
    s_mov_b64 exec, 1
    buffer_store_dword v15, off, s[44:47], 0 sc1
    s_mov_b64 exec, -1
FIN:
    s_waitcnt vmcnt(0)
EXIT:
    s_endpgm
G_SUB:
    s_lshl_b32 s86, s74, 3
    s_add_u32 s86, s86, s50
    s_mul_i32 s86, s86, 112
    s_mul_i32 s87, s49, 28
    s_add_u32 s86, s86, s87
    s_lshl_b32 s86, s86, 7
    s_and_b32 s87, s52, 2
    s_lshl_b32 s87, s87, 5
    s_add_u32 s86, s86, s87
    s_add_u32 s73, s86, 626688
    s_lshl_b32 s86, s74, 5
    s_add_u32 s86, s86, s52
    s_mul_i32 s87, s86, 57344
    s_mul_i32 s88, s49, 14336
    s_add_u32 s87, s87, s88
    s_add_u32 s75, s87, 24117248
    s_mul_i32 s88, s53, 2560
    s_mul_i32 s89, s49, 640
    s_add_u32 s88, s88, s89
    s_mul_i32 s87, s86, 20480
    s_add_u32 s87, s87, s88
    s_add_u32 s78, s87, 14680064
    s_add_u32 s80, s87, 20578304
    s_and_b32 s86, s86, 127
    s_mul_i32 s87, s86, 20480
    s_mul_i32 s88, s53, 160
    s_add_u32 s6, s87, s88
    s_cmp_ge_u32 s74, 4
    s_cselect_b32 s80, s6, s80
    s_mov_b32 s56, s44
    s_mov_b32 s57, s45
    s_cselect_b32 s58, 0, s46
    s_cselect_b32 s42, 2621440, 0
    s_cselect_b32 s10, 41943040, 0
    s_mov_b32 s69, 65536
POLL_17:
    buffer_load_dword v14, v9, s[44:47], s73 offen sc1
    s_waitcnt vmcnt(0)
    v_cmp_ne_u32 vcc, s48, v14
    s_cbranch_vccz PDONE_18
    s_sub_u32 s69, s69, 1
    s_cbranch_scc0 POLL_17
PDONE_18:
    s_mov_b32 m0, s83
    s_nop 0
    buffer_load_dwordx4 v1, s[44:47], s75 offen offset:0 sc1 lds
    buffer_load_dwordx4 v1, s[44:47], s75 offen offset:1024 sc1 lds
    buffer_load_dwordx4 v1, s[44:47], s75 offen offset:2048 sc1 lds
    buffer_load_dwordx4 v1, s[44:47], s75 offen offset:3072 sc1 lds
    s_add_u32 m0, m0, 4096
    s_add_u32 s75, s75, 4096
    buffer_load_dwordx4 v1, s[44:47], s75 offen offset:0 sc1 lds
    buffer_load_dwordx4 v1, s[44:47], s75 offen offset:1024 sc1 lds
    buffer_load_dwordx4 v1, s[44:47], s75 offen offset:2048 sc1 lds
    buffer_load_dwordx4 v1, s[44:47], s75 offen offset:3072 sc1 lds
    s_add_u32 m0, m0, 4096
    s_add_u32 s75, s75, 4096
    buffer_load_dwordx4 v1, s[44:47], s75 offen offset:0 sc1 lds
    buffer_load_dwordx4 v1, s[44:47], s75 offen offset:1024 sc1 lds
    buffer_load_dwordx4 v1, s[44:47], s75 offen offset:2048 sc1 lds
    buffer_load_dwordx4 v1, s[44:47], s75 offen offset:3072 sc1 lds
    s_add_u32 m0, m0, 4096
    s_add_u32 s75, s75, s33
    buffer_load_dwordx4 v1, s[44:47], s75 offen offset:0 sc1 lds
    buffer_load_dwordx4 v1, s[44:47], s75 offen offset:1024 sc1 lds
    s_add_u32 m0, s83, 14336
    s_mov_b32 exec_hi, 0xff
    buffer_load_dwordx4 v1, s[8:11], s78 offen sc1 lds
    s_mov_b32 exec_hi, -1
    s_waitcnt vmcnt(14)
    ds_read_b128 v[48:51], v7 offset:0
    s_waitcnt vmcnt(13)
    ds_read_b128 v[52:55], v7 offset:1024
    s_waitcnt lgkmcnt(1)
    v_mfma_f32_16x16x32_bf16 v[16:19], v[232:235], v[48:51], 0
    s_waitcnt vmcnt(12)
    ds_read_b128 v[56:59], v7 offset:2048
    v_mfma_f32_16x16x32_bf16 v[20:23], v[236:239], v[48:51], 0
    v_mfma_f32_16x16x32_bf16 v[24:27], v[240:243], v[48:51], 0
    v_mfma_f32_16x16x32_bf16 v[28:31], v[244:247], v[48:51], 0
    v_mfma_f32_16x16x32_bf16 v[60:63], v[248:251], v[48:51], 0
    s_waitcnt lgkmcnt(1)
    v_mfma_f32_16x16x32_bf16 v[16:19], v[252:255], v[52:55], v[16:19]
    s_waitcnt vmcnt(11)
    ds_read_b128 v[48:51], v7 offset:3072
    v_mfma_f32_16x16x32_bf16 v[20:23], a[0:3], v[52:55], v[20:23]
    v_mfma_f32_16x16x32_bf16 v[24:27], a[32:35], v[52:55], v[24:27]
    v_mfma_f32_16x16x32_bf16 v[28:31], a[64:67], v[52:55], v[28:31]
    v_mfma_f32_16x16x32_bf16 v[60:63], a[96:99], v[52:55], v[60:63]
    s_waitcnt lgkmcnt(1)
    v_mfma_f32_16x16x32_bf16 v[16:19], a[156:159], v[56:59], v[16:19]
    s_waitcnt vmcnt(10)
    ds_read_b128 v[52:55], v7 offset:4096
    v_mfma_f32_16x16x32_bf16 v[20:23], a[188:191], v[56:59], v[20:23]
    v_mfma_f32_16x16x32_bf16 v[24:27], a[220:223], v[56:59], v[24:27]
    v_mfma_f32_16x16x32_bf16 v[28:31], a[252:255], v[56:59], v[28:31]
    v_mfma_f32_16x16x32_bf16 v[60:63], a[4:7], v[56:59], v[60:63]
    s_waitcnt lgkmcnt(1)
    v_mfma_f32_16x16x32_bf16 v[16:19], a[36:39], v[48:51], v[16:19]
    s_waitcnt vmcnt(9)
    ds_read_b128 v[56:59], v7 offset:5120
    v_mfma_f32_16x16x32_bf16 v[20:23], a[68:71], v[48:51], v[20:23]
    v_mfma_f32_16x16x32_bf16 v[24:27], a[100:103], v[48:51], v[24:27]
    v_mfma_f32_16x16x32_bf16 v[28:31], a[152:155], v[48:51], v[28:31]
    v_mfma_f32_16x16x32_bf16 v[60:63], a[184:187], v[48:51], v[60:63]
    s_waitcnt lgkmcnt(1)
    v_mfma_f32_16x16x32_bf16 v[16:19], a[216:219], v[52:55], v[16:19]
    s_waitcnt vmcnt(8)
    ds_read_b128 v[48:51], v7 offset:6144
    v_mfma_f32_16x16x32_bf16 v[20:23], a[248:251], v[52:55], v[20:23]
    v_mfma_f32_16x16x32_bf16 v[24:27], a[8:11], v[52:55], v[24:27]
    v_mfma_f32_16x16x32_bf16 v[28:31], a[40:43], v[52:55], v[28:31]
    v_mfma_f32_16x16x32_bf16 v[60:63], a[72:75], v[52:55], v[60:63]
    s_waitcnt lgkmcnt(1)
    v_mfma_f32_16x16x32_bf16 v[16:19], a[104:107], v[56:59], v[16:19]
    s_waitcnt vmcnt(7)
    ds_read_b128 v[52:55], v7 offset:7168
    v_mfma_f32_16x16x32_bf16 v[20:23], a[148:151], v[56:59], v[20:23]
    v_mfma_f32_16x16x32_bf16 v[24:27], a[180:183], v[56:59], v[24:27]
    v_mfma_f32_16x16x32_bf16 v[28:31], a[212:215], v[56:59], v[28:31]
    v_mfma_f32_16x16x32_bf16 v[60:63], a[244:247], v[56:59], v[60:63]
    s_waitcnt lgkmcnt(1)
    v_mfma_f32_16x16x32_bf16 v[16:19], a[12:15], v[48:51], v[16:19]
    s_waitcnt vmcnt(6)
    ds_read_b128 v[56:59], v7 offset:8192
    v_mfma_f32_16x16x32_bf16 v[20:23], a[44:47], v[48:51], v[20:23]
    v_mfma_f32_16x16x32_bf16 v[24:27], a[76:79], v[48:51], v[24:27]
    v_mfma_f32_16x16x32_bf16 v[28:31], a[108:111], v[48:51], v[28:31]
    v_mfma_f32_16x16x32_bf16 v[60:63], a[144:147], v[48:51], v[60:63]
    s_waitcnt lgkmcnt(1)
    v_mfma_f32_16x16x32_bf16 v[16:19], a[176:179], v[52:55], v[16:19]
    s_waitcnt vmcnt(5)
    ds_read_b128 v[48:51], v7 offset:9216
    v_mfma_f32_16x16x32_bf16 v[20:23], a[208:211], v[52:55], v[20:23]
    v_mfma_f32_16x16x32_bf16 v[24:27], a[240:243], v[52:55], v[24:27]
    v_mfma_f32_16x16x32_bf16 v[28:31], a[16:19], v[52:55], v[28:31]
    v_mfma_f32_16x16x32_bf16 v[60:63], a[48:51], v[52:55], v[60:63]
    s_waitcnt lgkmcnt(1)
    v_mfma_f32_16x16x32_bf16 v[16:19], a[80:83], v[56:59], v[16:19]
    s_waitcnt vmcnt(4)
    ds_read_b128 v[52:55], v7 offset:10240
    v_mfma_f32_16x16x32_bf16 v[20:23], a[112:115], v[56:59], v[20:23]
    v_mfma_f32_16x16x32_bf16 v[24:27], a[140:143], v[56:59], v[24:27]
    v_mfma_f32_16x16x32_bf16 v[28:31], a[172:175], v[56:59], v[28:31]
    v_mfma_f32_16x16x32_bf16 v[60:63], a[204:207], v[56:59], v[60:63]
    s_waitcnt lgkmcnt(1)
    v_mfma_f32_16x16x32_bf16 v[16:19], a[236:239], v[48:51], v[16:19]
    s_waitcnt vmcnt(3)
    ds_read_b128 v[56:59], v7 offset:11264
    v_mfma_f32_16x16x32_bf16 v[20:23], a[24:27], v[48:51], v[20:23]
    v_mfma_f32_16x16x32_bf16 v[24:27], a[56:59], v[48:51], v[24:27]
    v_mfma_f32_16x16x32_bf16 v[28:31], a[88:91], v[48:51], v[28:31]
    v_mfma_f32_16x16x32_bf16 v[60:63], a[120:123], v[48:51], v[60:63]
    s_waitcnt lgkmcnt(1)
    v_mfma_f32_16x16x32_bf16 v[16:19], a[132:135], v[52:55], v[16:19]
    s_waitcnt vmcnt(2)
    ds_read_b128 v[48:51], v7 offset:12288
    v_mfma_f32_16x16x32_bf16 v[20:23], a[164:167], v[52:55], v[20:23]
    v_mfma_f32_16x16x32_bf16 v[24:27], a[196:199], v[52:55], v[24:27]
    v_mfma_f32_16x16x32_bf16 v[28:31], a[228:231], v[52:55], v[28:31]
    v_mfma_f32_16x16x32_bf16 v[60:63], a[20:23], v[52:55], v[60:63]
    s_waitcnt lgkmcnt(1)
    v_mfma_f32_16x16x32_bf16 v[16:19], a[52:55], v[56:59], v[16:19]
    s_waitcnt vmcnt(1)
    ds_read_b128 v[52:55], v7 offset:13312
    v_mfma_f32_16x16x32_bf16 v[20:23], a[84:87], v[56:59], v[20:23]
    v_mfma_f32_16x16x32_bf16 v[24:27], a[116:119], v[56:59], v[24:27]
    v_mfma_f32_16x16x32_bf16 v[28:31], a[136:139], v[56:59], v[28:31]
    v_mfma_f32_16x16x32_bf16 v[60:63], a[168:171], v[56:59], v[60:63]
    s_waitcnt lgkmcnt(1)
    v_mfma_f32_16x16x32_bf16 v[16:19], a[200:203], v[48:51], v[16:19]
    v_mfma_f32_16x16x32_bf16 v[20:23], a[232:235], v[48:51], v[20:23]
    s_barrier
    v_mfma_f32_16x16x32_bf16 v[24:27], a[28:31], v[48:51], v[24:27]
    v_mfma_f32_16x16x32_bf16 v[28:31], a[60:63], v[48:51], v[28:31]
    v_mfma_f32_16x16x32_bf16 v[60:63], a[92:95], v[48:51], v[60:63]
    s_waitcnt lgkmcnt(0)
    v_mfma_f32_16x16x32_bf16 v[16:19], a[124:127], v[52:55], v[16:19]
    v_mfma_f32_16x16x32_bf16 v[20:23], a[128:131], v[52:55], v[20:23]
    v_mfma_f32_16x16x32_bf16 v[24:27], a[160:163], v[52:55], v[24:27]
    s_nop 1
    ds_write_b128 v11, v[16:19] offset:0
    v_mfma_f32_16x16x32_bf16 v[28:31], a[192:195], v[52:55], v[28:31]
    s_nop 0
    ds_write_b128 v11, v[20:23] offset:64
    v_mfma_f32_16x16x32_bf16 v[60:63], a[224:227], v[52:55], v[60:63]
    s_nop 0
    ds_write_b128 v11, v[24:27] offset:128
    s_nop 2
    ds_write_b128 v11, v[28:31] offset:192
    s_nop 1
    ds_write_b128 v11, v[60:63] offset:256
    s_waitcnt lgkmcnt(0)
    s_barrier
    ds_read_b128 v[32:35], v12 offset:0
    ds_read_b128 v[40:43], v12 offset:5376
    ds_read_b128 v[36:39], v12 offset:16
    ds_read_b128 v[44:47], v12 offset:5392
    ds_read_b128 v[64:67], v12 offset:10752
    ds_read_b128 v[68:71], v12 offset:10768
    s_waitcnt lgkmcnt(4)
    v_pk_add_f32 v[32:33], v[32:33], v[40:41]
    v_pk_add_f32 v[34:35], v[34:35], v[42:43]
    s_waitcnt lgkmcnt(2)
    v_pk_add_f32 v[36:37], v[36:37], v[44:45]
    v_pk_add_f32 v[38:39], v[38:39], v[46:47]
    ds_read_b128 v[40:43], v12 offset:16128
    ds_read_b128 v[44:47], v12 offset:16144
    s_waitcnt lgkmcnt(3)
    v_pk_add_f32 v[32:33], v[32:33], v[64:65]
    v_pk_add_f32 v[34:35], v[34:35], v[66:67]
    s_waitcnt lgkmcnt(2)
    v_pk_add_f32 v[36:37], v[36:37], v[68:69]
    v_pk_add_f32 v[38:39], v[38:39], v[70:71]
    s_waitcnt vmcnt(0)
    ds_read_b128 v[64:67], v7 offset:14336
    s_waitcnt lgkmcnt(2)
    v_pk_add_f32 v[32:33], v[32:33], v[40:41]
    v_pk_add_f32 v[34:35], v[34:35], v[42:43]
    s_waitcnt lgkmcnt(1)
    v_pk_add_f32 v[36:37], v[36:37], v[44:45]
    v_pk_add_f32 v[38:39], v[38:39], v[46:47]
    s_waitcnt lgkmcnt(0)
    v_lshlrev_b32 v68, 16, v64
    v_and_b32 v69, 0xffff0000, v64
    v_lshlrev_b32 v70, 16, v65
    v_and_b32 v71, 0xffff0000, v65
    v_pk_fma_f32 v[32:33], v[32:33], s[100:101], v[68:69] op_sel:[0,1,0] op_sel_hi:[1,1,1]
    v_pk_fma_f32 v[34:35], v[34:35], s[100:101], v[70:71] op_sel:[0,1,0] op_sel_hi:[1,1,1]
    v_cvt_pk_bf16_f32 v64, v32, v33
    v_cvt_pk_bf16_f32 v65, v34, v35
    v_lshlrev_b32 v68, 16, v66
    v_and_b32 v69, 0xffff0000, v66
    v_lshlrev_b32 v70, 16, v67
    v_and_b32 v71, 0xffff0000, v67
    v_pk_fma_f32 v[36:37], v[36:37], s[100:101], v[68:69] op_sel:[0,1,0] op_sel_hi:[1,1,1]
    v_pk_fma_f32 v[38:39], v[38:39], s[100:101], v[70:71] op_sel:[0,1,0] op_sel_hi:[1,1,1]
    v_cvt_pk_bf16_f32 v66, v36, v37
    v_cvt_pk_bf16_f32 v67, v38, v39
    s_mov_b32 exec_hi, 0xff
    buffer_store_dwordx4 v[64:67], v1, s[56:59], s80 offen sc1
    buffer_store_dwordx4 v[64:67], v13, s[40:43], s80 offen
    s_mov_b32 exec_hi, -1
    s_setpc_b64 s[92:93]
LN_PRE:
    v_pk_mul_f32 v[60:61], v[72:73], v[72:73]
    v_pk_mul_f32 v[62:63], v[74:75], v[74:75]
    v_pk_add_f32 v[56:57], v[72:73], v[74:75]
    v_pk_fma_f32 v[60:61], v[76:77], v[76:77], v[60:61]
    v_pk_fma_f32 v[62:63], v[78:79], v[78:79], v[62:63]
    v_pk_add_f32 v[58:59], v[76:77], v[78:79]
    v_pk_fma_f32 v[60:61], v[80:81], v[80:81], v[60:61]
    v_pk_add_f32 v[56:57], v[56:57], v[80:81]
    v_pk_fma_f32 v[62:63], v[82:83], v[82:83], v[62:63]
    v_pk_add_f32 v[58:59], v[58:59], v[82:83]
    v_pk_fma_f32 v[60:61], v[84:85], v[84:85], v[60:61]
    v_pk_add_f32 v[56:57], v[56:57], v[84:85]
    v_pk_fma_f32 v[62:63], v[86:87], v[86:87], v[62:63]
    v_pk_add_f32 v[58:59], v[58:59], v[86:87]
    v_pk_fma_f32 v[60:61], v[88:89], v[88:89], v[60:61]
    v_pk_add_f32 v[56:57], v[56:57], v[88:89]
    v_pk_fma_f32 v[62:63], v[90:91], v[90:91], v[62:63]
    v_pk_add_f32 v[58:59], v[58:59], v[90:91]
    v_pk_fma_f32 v[60:61], v[92:93], v[92:93], v[60:61]
    v_pk_add_f32 v[56:57], v[56:57], v[92:93]
    v_pk_fma_f32 v[62:63], v[94:95], v[94:95], v[62:63]
    v_pk_add_f32 v[58:59], v[58:59], v[94:95]
    v_pk_fma_f32 v[60:61], v[96:97], v[96:97], v[60:61]
    v_pk_add_f32 v[56:57], v[56:57], v[96:97]
    v_pk_fma_f32 v[62:63], v[98:99], v[98:99], v[62:63]
    v_pk_add_f32 v[58:59], v[58:59], v[98:99]
    v_pk_fma_f32 v[60:61], v[100:101], v[100:101], v[60:61]
    v_pk_add_f32 v[56:57], v[56:57], v[100:101]
    v_pk_fma_f32 v[62:63], v[102:103], v[102:103], v[62:63]
    v_pk_add_f32 v[58:59], v[58:59], v[102:103]
    v_pk_fma_f32 v[60:61], v[104:105], v[104:105], v[60:61]
    v_pk_add_f32 v[56:57], v[56:57], v[104:105]
    v_pk_fma_f32 v[62:63], v[106:107], v[106:107], v[62:63]
    v_pk_add_f32 v[58:59], v[58:59], v[106:107]
    v_pk_fma_f32 v[60:61], v[108:109], v[108:109], v[60:61]
    v_pk_add_f32 v[56:57], v[56:57], v[108:109]
    v_pk_fma_f32 v[62:63], v[110:111], v[110:111], v[62:63]
    v_pk_add_f32 v[58:59], v[58:59], v[110:111]
    v_pk_add_f32 v[56:57], v[56:57], v[58:59]
    v_pk_add_f32 v[60:61], v[60:61], v[62:63]
    v_add_f32 v56, v56, v57
    v_add_f32 v60, v60, v61
    s_nop 0
    v_add_f32_dpp v56, v56, v56 row_ror:8 row_mask:0xf bank_mask:0xf
    v_add_f32_dpp v60, v60, v60 row_ror:8 row_mask:0xf bank_mask:0xf
    s_nop 0
    v_add_f32_dpp v56, v56, v56 row_ror:4 row_mask:0xf bank_mask:0xf
    v_add_f32_dpp v60, v60, v60 row_ror:4 row_mask:0xf bank_mask:0xf
    s_nop 0
    v_add_f32_dpp v56, v56, v56 row_ror:2 row_mask:0xf bank_mask:0xf
    v_add_f32_dpp v60, v60, v60 row_ror:2 row_mask:0xf bank_mask:0xf
    s_nop 0
    v_add_f32_dpp v56, v56, v56 row_ror:1 row_mask:0xf bank_mask:0xf
    v_add_f32_dpp v60, v60, v60 row_ror:1 row_mask:0xf bank_mask:0xf
    v_mul_f32 v56, 0x3acccccd, v56
    v_mul_f32 v57, v56, v56
    v_fma_f32 v57, v60, s7, -v57
    v_max_f32 v57, 0, v57
    v_add_f32 v57, 0x3727c5ac, v57
    v_rsq_f32 v58, v57
    s_nop 0
    v_mul_f32 v56, v56, v58
    s_setpc_b64 s[94:95]
LN1B:
    s_mov_b32 s71, s76
    s_lshl_b32 s87, s68, 5
    s_add_u32 s87, s87, s54
    s_mul_i32 s86, s87, 20480
    s_add_u32 s70, s86, 14680064
    s_add_u32 s81, s86, 9437184
    s_add_u32 s88, s86, 6291456
    s_lshl_b32 s89, s87, 2
    s_add_u32 s89, s89, s49
    s_lshl_b32 s89, s89, 7
    s_add_u32 s76, s89, 462848
    s_mul_i32 s90, s49, 5120
    s_add_u32 s90, s90, 20480
    s_add_u32 s88, s88, s90
    s_add_u32 s88, s88, 634880
    s_mul_i32 s91, s68, 20480
    s_add_u32 m0, s91, s90
    v_pk_fma_f32 v[112:113], v[72:73], v[142:143], v[142:143] op_sel:[0,0,1] op_sel_hi:[1,0,1] neg_lo:[0,0,1] neg_hi:[0,0,1]
    v_pk_fma_f32 v[114:115], v[74:75], v[142:143], v[142:143] op_sel:[0,0,1] op_sel_hi:[1,0,1] neg_lo:[0,0,1] neg_hi:[0,0,1]
    v_pk_fma_f32 v[116:117], v[76:77], v[142:143], v[142:143] op_sel:[0,0,1] op_sel_hi:[1,0,1] neg_lo:[0,0,1] neg_hi:[0,0,1]
    v_pk_fma_f32 v[118:119], v[78:79], v[142:143], v[142:143] op_sel:[0,0,1] op_sel_hi:[1,0,1] neg_lo:[0,0,1] neg_hi:[0,0,1]
    v_pk_fma_f32 v[120:121], v[80:81], v[142:143], v[142:143] op_sel:[0,0,1] op_sel_hi:[1,0,1] neg_lo:[0,0,1] neg_hi:[0,0,1]
    v_pk_fma_f32 v[122:123], v[82:83], v[142:143], v[142:143] op_sel:[0,0,1] op_sel_hi:[1,0,1] neg_lo:[0,0,1] neg_hi:[0,0,1]
    v_pk_fma_f32 v[124:125], v[84:85], v[142:143], v[142:143] op_sel:[0,0,1] op_sel_hi:[1,0,1] neg_lo:[0,0,1] neg_hi:[0,0,1]
    v_pk_fma_f32 v[126:127], v[86:87], v[142:143], v[142:143] op_sel:[0,0,1] op_sel_hi:[1,0,1] neg_lo:[0,0,1] neg_hi:[0,0,1]
    s_waitcnt vmcnt(5)
    s_barrier
    ds_read2st64_b64 v[16:19], v10 offset0:0 offset1:1
    ds_read2st64_b64 v[20:23], v10 offset0:8 offset1:9
    ds_read2st64_b64 v[24:27], v10 offset0:16 offset1:17
    ds_read2st64_b64 v[28:31], v10 offset0:24 offset1:25
    ds_read2st64_b64 v[32:35], v10 offset0:32 offset1:33
    v_add_u32 v10, 20480, v10
    s_add_u32 s14, s14, 81920
    s_waitcnt lgkmcnt(4)
    v_lshlrev_b32 v64, 16, v16
    v_and_b32 v65, s15, v16
    v_pk_fma_f32 v[72:73], v[64:65], v[112:113], v[72:73]
    v_lshlrev_b32 v66, 16, v17
    v_and_b32 v67, s15, v17
    v_pk_fma_f32 v[74:75], v[66:67], v[114:115], v[74:75]
    v_pk_fma_f32 v[112:113], v[88:89], v[142:143], v[142:143] op_sel:[0,0,1] op_sel_hi:[1,0,1] neg_lo:[0,0,1] neg_hi:[0,0,1]
    v_lshlrev_b32 v64, 16, v18
    v_and_b32 v65, s15, v18
    v_pk_mul_f32 v[60:61], v[72:73], v[72:73]
    v_pk_fma_f32 v[76:77], v[64:65], v[116:117], v[76:77]
    v_pk_fma_f32 v[114:115], v[90:91], v[142:143], v[142:143] op_sel:[0,0,1] op_sel_hi:[1,0,1] neg_lo:[0,0,1] neg_hi:[0,0,1]
    v_lshlrev_b32 v66, 16, v19
    v_and_b32 v67, s15, v19
    v_pk_mul_f32 v[62:63], v[74:75], v[74:75]
    v_pk_add_f32 v[56:57], v[72:73], v[74:75]
    v_pk_fma_f32 v[78:79], v[66:67], v[118:119], v[78:79]
    v_pk_fma_f32 v[116:117], v[92:93], v[142:143], v[142:143] op_sel:[0,0,1] op_sel_hi:[1,0,1] neg_lo:[0,0,1] neg_hi:[0,0,1]
    s_waitcnt lgkmcnt(3)
    v_lshlrev_b32 v64, 16, v20
    v_and_b32 v65, s15, v20
    v_pk_fma_f32 v[60:61], v[76:77], v[76:77], v[60:61]
    v_pk_fma_f32 v[80:81], v[64:65], v[120:121], v[80:81]
    v_pk_fma_f32 v[118:119], v[94:95], v[142:143], v[142:143] op_sel:[0,0,1] op_sel_hi:[1,0,1] neg_lo:[0,0,1] neg_hi:[0,0,1]
    v_lshlrev_b32 v66, 16, v21
    v_and_b32 v67, s15, v21
    v_pk_fma_f32 v[62:63], v[78:79], v[78:79], v[62:63]
    v_pk_add_f32 v[58:59], v[76:77], v[78:79]
    v_pk_fma_f32 v[82:83], v[66:67], v[122:123], v[82:83]
    v_pk_fma_f32 v[120:121], v[96:97], v[142:143], v[142:143] op_sel:[0,0,1] op_sel_hi:[1,0,1] neg_lo:[0,0,1] neg_hi:[0,0,1]
    s_waitcnt vmcnt(0)
    s_mov_b64 exec, 1
    buffer_store_dword v15, off, s[44:47], s71 sc1
    s_mov_b64 exec, -1
    v_lshlrev_b32 v64, 16, v22
    v_and_b32 v65, s15, v22
    v_pk_fma_f32 v[60:61], v[80:81], v[80:81], v[60:61]
    v_pk_add_f32 v[56:57], v[56:57], v[80:81]
    v_pk_fma_f32 v[84:85], v[64:65], v[124:125], v[84:85]
    v_pk_fma_f32 v[122:123], v[98:99], v[142:143], v[142:143] op_sel:[0,0,1] op_sel_hi:[1,0,1] neg_lo:[0,0,1] neg_hi:[0,0,1]
    v_lshlrev_b32 v66, 16, v23
    v_and_b32 v67, s15, v23
    v_pk_fma_f32 v[62:63], v[82:83], v[82:83], v[62:63]
    v_pk_add_f32 v[58:59], v[58:59], v[82:83]
    v_pk_fma_f32 v[86:87], v[66:67], v[126:127], v[86:87]
    v_pk_fma_f32 v[124:125], v[100:101], v[142:143], v[142:143] op_sel:[0,0,1] op_sel_hi:[1,0,1] neg_lo:[0,0,1] neg_hi:[0,0,1]
    s_waitcnt lgkmcnt(2)
    v_lshlrev_b32 v64, 16, v24
    v_and_b32 v65, s15, v24
    v_pk_fma_f32 v[60:61], v[84:85], v[84:85], v[60:61]
    v_pk_add_f32 v[56:57], v[56:57], v[84:85]
    v_pk_fma_f32 v[88:89], v[64:65], v[112:113], v[88:89]
    v_pk_fma_f32 v[126:127], v[102:103], v[142:143], v[142:143] op_sel:[0,0,1] op_sel_hi:[1,0,1] neg_lo:[0,0,1] neg_hi:[0,0,1]
    v_lshlrev_b32 v66, 16, v25
    v_and_b32 v67, s15, v25
    v_pk_fma_f32 v[62:63], v[86:87], v[86:87], v[62:63]
    v_pk_add_f32 v[58:59], v[58:59], v[86:87]
    v_pk_fma_f32 v[90:91], v[66:67], v[114:115], v[90:91]
    v_pk_fma_f32 v[112:113], v[104:105], v[142:143], v[142:143] op_sel:[0,0,1] op_sel_hi:[1,0,1] neg_lo:[0,0,1] neg_hi:[0,0,1]
    v_lshlrev_b32 v64, 16, v26
    v_and_b32 v65, s15, v26
    v_pk_fma_f32 v[60:61], v[88:89], v[88:89], v[60:61]
    v_pk_add_f32 v[56:57], v[56:57], v[88:89]
    v_pk_fma_f32 v[92:93], v[64:65], v[116:117], v[92:93]
    v_pk_fma_f32 v[114:115], v[106:107], v[142:143], v[142:143] op_sel:[0,0,1] op_sel_hi:[1,0,1] neg_lo:[0,0,1] neg_hi:[0,0,1]
    v_lshlrev_b32 v66, 16, v27
    v_and_b32 v67, s15, v27
    v_pk_fma_f32 v[62:63], v[90:91], v[90:91], v[62:63]
    v_pk_add_f32 v[58:59], v[58:59], v[90:91]
    v_pk_fma_f32 v[94:95], v[66:67], v[118:119], v[94:95]
    v_pk_fma_f32 v[116:117], v[108:109], v[142:143], v[142:143] op_sel:[0,0,1] op_sel_hi:[1,0,1] neg_lo:[0,0,1] neg_hi:[0,0,1]
    s_waitcnt lgkmcnt(1)
    v_lshlrev_b32 v64, 16, v28
    v_and_b32 v65, s15, v28
    v_pk_fma_f32 v[60:61], v[92:93], v[92:93], v[60:61]
    v_pk_add_f32 v[56:57], v[56:57], v[92:93]
    v_pk_fma_f32 v[96:97], v[64:65], v[120:121], v[96:97]
    v_pk_fma_f32 v[118:119], v[110:111], v[142:143], v[142:143] op_sel:[0,0,1] op_sel_hi:[1,0,1] neg_lo:[0,0,1] neg_hi:[0,0,1]
    v_lshlrev_b32 v66, 16, v29
    v_and_b32 v67, s15, v29
    v_pk_fma_f32 v[62:63], v[94:95], v[94:95], v[62:63]
    v_pk_add_f32 v[58:59], v[58:59], v[94:95]
    v_pk_fma_f32 v[98:99], v[66:67], v[122:123], v[98:99]
    v_lshlrev_b32 v64, 16, v30
    v_and_b32 v65, s15, v30
    v_pk_fma_f32 v[60:61], v[96:97], v[96:97], v[60:61]
    v_pk_add_f32 v[56:57], v[56:57], v[96:97]
    v_pk_fma_f32 v[100:101], v[64:65], v[124:125], v[100:101]
    v_lshlrev_b32 v66, 16, v31
    v_and_b32 v67, s15, v31
    v_pk_fma_f32 v[62:63], v[98:99], v[98:99], v[62:63]
    v_pk_add_f32 v[58:59], v[58:59], v[98:99]
    v_pk_fma_f32 v[102:103], v[66:67], v[126:127], v[102:103]
    buffer_load_dword v14, v69, s[44:47], s14 offen sc1
    s_waitcnt lgkmcnt(0)
    v_lshlrev_b32 v64, 16, v32
    v_and_b32 v65, s15, v32
    v_pk_fma_f32 v[60:61], v[100:101], v[100:101], v[60:61]
    v_pk_add_f32 v[56:57], v[56:57], v[100:101]
    v_pk_fma_f32 v[104:105], v[64:65], v[112:113], v[104:105]
    v_lshlrev_b32 v66, 16, v33
    v_and_b32 v67, s15, v33
    v_pk_fma_f32 v[62:63], v[102:103], v[102:103], v[62:63]
    v_pk_add_f32 v[58:59], v[58:59], v[102:103]
    v_pk_fma_f32 v[106:107], v[66:67], v[114:115], v[106:107]
    v_lshlrev_b32 v64, 16, v34
    v_and_b32 v65, s15, v34
    v_pk_fma_f32 v[60:61], v[104:105], v[104:105], v[60:61]
    v_pk_add_f32 v[56:57], v[56:57], v[104:105]
    v_pk_fma_f32 v[108:109], v[64:65], v[116:117], v[108:109]
    v_lshlrev_b32 v66, 16, v35
    v_and_b32 v67, s15, v35
    v_pk_fma_f32 v[62:63], v[106:107], v[106:107], v[62:63]
    v_pk_add_f32 v[58:59], v[58:59], v[106:107]
    v_pk_fma_f32 v[110:111], v[66:67], v[118:119], v[110:111]
    v_pk_fma_f32 v[60:61], v[108:109], v[108:109], v[60:61]
    v_pk_add_f32 v[56:57], v[56:57], v[108:109]
    v_pk_fma_f32 v[62:63], v[110:111], v[110:111], v[62:63]
    v_pk_add_f32 v[58:59], v[58:59], v[110:111]
    v_pk_add_f32 v[56:57], v[56:57], v[58:59]
    v_pk_add_f32 v[60:61], v[60:61], v[62:63]
    v_cvt_pk_bf16_f32 v16, v72, v73
    v_add_f32 v56, v56, v57
    v_add_f32 v60, v60, v61
    v_cvt_pk_bf16_f32 v17, v74, v75
    v_cvt_pk_bf16_f32 v18, v76, v77
    v_add_f32_dpp v56, v56, v56 row_ror:8 row_mask:0xf bank_mask:0xf
    v_add_f32_dpp v60, v60, v60 row_ror:8 row_mask:0xf bank_mask:0xf
    v_cvt_pk_bf16_f32 v19, v78, v79
    v_cvt_pk_bf16_f32 v20, v80, v81
    v_add_f32_dpp v56, v56, v56 row_ror:4 row_mask:0xf bank_mask:0xf
    v_add_f32_dpp v60, v60, v60 row_ror:4 row_mask:0xf bank_mask:0xf
    v_cvt_pk_bf16_f32 v21, v82, v83
    v_cvt_pk_bf16_f32 v22, v84, v85
    v_add_f32_dpp v56, v56, v56 row_ror:2 row_mask:0xf bank_mask:0xf
    v_add_f32_dpp v60, v60, v60 row_ror:2 row_mask:0xf bank_mask:0xf
    v_cvt_pk_bf16_f32 v23, v86, v87
    v_cvt_pk_bf16_f32 v24, v88, v89
    v_add_f32_dpp v56, v56, v56 row_ror:1 row_mask:0xf bank_mask:0xf
    v_add_f32_dpp v60, v60, v60 row_ror:1 row_mask:0xf bank_mask:0xf
    v_cvt_pk_bf16_f32 v25, v90, v91
    v_mul_f32 v56, 0x3acccccd, v56
    v_cvt_pk_bf16_f32 v26, v92, v93
    v_cvt_pk_bf16_f32 v27, v94, v95
    v_mul_f32 v57, v56, v56
    v_cvt_pk_bf16_f32 v28, v96, v97
    v_cvt_pk_bf16_f32 v29, v98, v99
    v_fma_f32 v57, v60, s7, -v57
    v_cvt_pk_bf16_f32 v30, v100, v101
    v_cvt_pk_bf16_f32 v31, v102, v103
    v_max_f32 v57, 0, v57
    v_cvt_pk_bf16_f32 v32, v104, v105
    v_cvt_pk_bf16_f32 v33, v106, v107
    v_add_f32 v57, 0x3727c5ac, v57
    v_cvt_pk_bf16_f32 v34, v108, v109
    v_cvt_pk_bf16_f32 v35, v110, v111
    v_rsq_f32 v58, v57
    s_nop 0
    v_mul_f32 v58, 0x3eeff558, v58
    v_mul_f32 v56, v56, v58
    s_add_u32 s86, s81, 4096
    s_add_u32 s87, s81, 8192
    v_pk_fma_f32 v[112:113], v[72:73], v[58:59], v[56:57] op_sel_hi:[1,0,0] neg_lo:[0,0,1] neg_hi:[0,0,1]
    v_pk_fma_f32 v[114:115], v[74:75], v[58:59], v[56:57] op_sel_hi:[1,0,0] neg_lo:[0,0,1] neg_hi:[0,0,1]
    v_pk_fma_f32 v[116:117], v[76:77], v[58:59], v[56:57] op_sel_hi:[1,0,0] neg_lo:[0,0,1] neg_hi:[0,0,1]
    v_cvt_pk_bf16_f32 v36, v112, v113
    v_pk_fma_f32 v[118:119], v[78:79], v[58:59], v[56:57] op_sel_hi:[1,0,0] neg_lo:[0,0,1] neg_hi:[0,0,1]
    v_cvt_pk_bf16_f32 v37, v114, v115
    v_pk_fma_f32 v[120:121], v[80:81], v[58:59], v[56:57] op_sel_hi:[1,0,0] neg_lo:[0,0,1] neg_hi:[0,0,1]
    v_cvt_pk_bf16_f32 v38, v116, v117
    s_waitcnt vmcnt(0)
    v_cmp_ne_u32 vcc, s48, v14
    s_cmp_eq_u64 vcc, 0
    s_cselect_b32 s62, 41943040, 0
    s_cmp_eq_u32 s68, 3
    s_cselect_b32 s62, 0, s62
    buffer_load_dwordx4 v68, s[60:63], s88 offen offset:0 sc1 lds
    buffer_load_dwordx4 v68, s[60:63], s88 offen offset:1024 sc1 lds
    buffer_load_dwordx4 v68, s[60:63], s88 offen offset:2048 sc1 lds
    buffer_load_dwordx4 v68, s[60:63], s88 offen offset:3072 sc1 lds
    s_add_u32 m0, m0, 4096
    s_add_u32 s88, s88, 4096
    buffer_load_dwordx4 v68, s[60:63], s88 offen sc1 lds
    v_pk_fma_f32 v[122:123], v[82:83], v[58:59], v[56:57] op_sel_hi:[1,0,0] neg_lo:[0,0,1] neg_hi:[0,0,1]
    v_cvt_pk_bf16_f32 v39, v118, v119
    v_pk_fma_f32 v[124:125], v[84:85], v[58:59], v[56:57] op_sel_hi:[1,0,0] neg_lo:[0,0,1] neg_hi:[0,0,1]
    v_cvt_pk_bf16_f32 v40, v120, v121
    buffer_store_dwordx4 v[36:39], v8, s[44:47], s81 offen offset:0 sc1
    v_pk_fma_f32 v[126:127], v[86:87], v[58:59], v[56:57] op_sel_hi:[1,0,0] neg_lo:[0,0,1] neg_hi:[0,0,1]
    v_cvt_pk_bf16_f32 v41, v122, v123
    v_pk_fma_f32 v[112:113], v[88:89], v[58:59], v[56:57] op_sel_hi:[1,0,0] neg_lo:[0,0,1] neg_hi:[0,0,1]
    v_cvt_pk_bf16_f32 v42, v124, v125
    v_pk_fma_f32 v[114:115], v[90:91], v[58:59], v[56:57] op_sel_hi:[1,0,0] neg_lo:[0,0,1] neg_hi:[0,0,1]
    v_cvt_pk_bf16_f32 v43, v126, v127
    v_pk_fma_f32 v[116:117], v[92:93], v[58:59], v[56:57] op_sel_hi:[1,0,0] neg_lo:[0,0,1] neg_hi:[0,0,1]
    v_cvt_pk_bf16_f32 v44, v112, v113
    buffer_store_dwordx4 v[40:43], v8, s[44:47], s81 offen offset:2048 sc1
    v_pk_fma_f32 v[118:119], v[94:95], v[58:59], v[56:57] op_sel_hi:[1,0,0] neg_lo:[0,0,1] neg_hi:[0,0,1]
    v_cvt_pk_bf16_f32 v45, v114, v115
    v_pk_fma_f32 v[120:121], v[96:97], v[58:59], v[56:57] op_sel_hi:[1,0,0] neg_lo:[0,0,1] neg_hi:[0,0,1]
    v_cvt_pk_bf16_f32 v46, v116, v117
    v_pk_fma_f32 v[122:123], v[98:99], v[58:59], v[56:57] op_sel_hi:[1,0,0] neg_lo:[0,0,1] neg_hi:[0,0,1]
    v_cvt_pk_bf16_f32 v47, v118, v119
    v_pk_fma_f32 v[124:125], v[100:101], v[58:59], v[56:57] op_sel_hi:[1,0,0] neg_lo:[0,0,1] neg_hi:[0,0,1]
    v_cvt_pk_bf16_f32 v48, v120, v121
    buffer_store_dwordx4 v[44:47], v8, s[44:47], s86 offen offset:0 sc1
    v_pk_fma_f32 v[126:127], v[102:103], v[58:59], v[56:57] op_sel_hi:[1,0,0] neg_lo:[0,0,1] neg_hi:[0,0,1]
    v_cvt_pk_bf16_f32 v49, v122, v123
    v_pk_fma_f32 v[112:113], v[104:105], v[58:59], v[56:57] op_sel_hi:[1,0,0] neg_lo:[0,0,1] neg_hi:[0,0,1]
    v_cvt_pk_bf16_f32 v50, v124, v125
    v_pk_fma_f32 v[114:115], v[106:107], v[58:59], v[56:57] op_sel_hi:[1,0,0] neg_lo:[0,0,1] neg_hi:[0,0,1]
    v_cvt_pk_bf16_f32 v51, v126, v127
    v_pk_fma_f32 v[116:117], v[108:109], v[58:59], v[56:57] op_sel_hi:[1,0,0] neg_lo:[0,0,1] neg_hi:[0,0,1]
    v_cvt_pk_bf16_f32 v52, v112, v113
    buffer_store_dwordx4 v[48:51], v8, s[44:47], s86 offen offset:2048 sc1
    v_pk_fma_f32 v[118:119], v[110:111], v[58:59], v[56:57] op_sel_hi:[1,0,0] neg_lo:[0,0,1] neg_hi:[0,0,1]
    v_cvt_pk_bf16_f32 v53, v114, v115
    v_cvt_pk_bf16_f32 v54, v116, v117
    v_cvt_pk_bf16_f32 v55, v118, v119
    buffer_store_dwordx4 v[52:55], v8, s[44:47], s87 offen offset:0 sc1
    s_setpc_b64 s[92:93]
WD_ALL:
    s_mul_i32 s86, s49, 14
    v_add_u32 v70, s86, v0
    s_add_u32 s87, s86, 13
    s_min_u32 s87, s87, 53
    v_min_u32 v70, s87, v70
    v_lshlrev_b32 v70, 9, v70
    s_lshr_b32 s89, s53, 1
    s_lshl_b32 s89, s89, 7
    s_add_u32 s89, s89, 593920
    s_mul_i32 s84, s53, 54
    s_add_u32 s84, s84, s86
    s_mul_i32 s84, s84, 5120
    s_add_u32 s84, s84, 38797312
    s_mov_b32 s69, 65536
POLL_19:
    buffer_load_dword v14, v70, s[44:47], s89 offen sc1
    s_waitcnt vmcnt(0)
    v_cmp_ne_u32 vcc, s48, v14
    s_cbranch_vccz PDONE_20
    s_sub_u32 s69, s69, 1
    s_cbranch_scc0 POLL_19
PDONE_20:
    buffer_load_dwordx4 v[232:235], v1, s[44:47], s84 offen offset:0 sc1
    buffer_load_dwordx4 v[236:239], v1, s[44:47], s84 offen offset:1024 sc1
    buffer_load_dwordx4 v[240:243], v1, s[44:47], s84 offen offset:2048 sc1
    buffer_load_dwordx4 v[244:247], v1, s[44:47], s84 offen offset:3072 sc1
    s_add_u32 s84, s84, 4096
    buffer_load_dwordx4 v[248:251], v1, s[44:47], s84 offen offset:0 sc1
    buffer_load_dwordx4 v[252:255], v1, s[44:47], s84 offen offset:1024 sc1
    buffer_load_dwordx4 a[0:3], v1, s[44:47], s84 offen offset:2048 sc1
    buffer_load_dwordx4 a[32:35], v1, s[44:47], s84 offen offset:3072 sc1
    s_add_u32 s84, s84, 4096
    buffer_load_dwordx4 a[64:67], v1, s[44:47], s84 offen offset:0 sc1
    buffer_load_dwordx4 a[96:99], v1, s[44:47], s84 offen offset:1024 sc1
    buffer_load_dwordx4 a[156:159], v1, s[44:47], s84 offen offset:2048 sc1
    buffer_load_dwordx4 a[188:191], v1, s[44:47], s84 offen offset:3072 sc1
    s_add_u32 s84, s84, 4096
    buffer_load_dwordx4 a[220:223], v1, s[44:47], s84 offen offset:0 sc1
    buffer_load_dwordx4 a[252:255], v1, s[44:47], s84 offen offset:1024 sc1
    buffer_load_dwordx4 a[4:7], v1, s[44:47], s84 offen offset:2048 sc1
    buffer_load_dwordx4 a[36:39], v1, s[44:47], s84 offen offset:3072 sc1
    s_add_u32 s84, s84, 4096
    buffer_load_dwordx4 a[68:71], v1, s[44:47], s84 offen offset:0 sc1
    buffer_load_dwordx4 a[100:103], v1, s[44:47], s84 offen offset:1024 sc1
    buffer_load_dwordx4 a[152:155], v1, s[44:47], s84 offen offset:2048 sc1
    buffer_load_dwordx4 a[184:187], v1, s[44:47], s84 offen offset:3072 sc1
    s_add_u32 s84, s84, 4096
    buffer_load_dwordx4 a[216:219], v1, s[44:47], s84 offen offset:0 sc1
    buffer_load_dwordx4 a[248:251], v1, s[44:47], s84 offen offset:1024 sc1
    buffer_load_dwordx4 a[8:11], v1, s[44:47], s84 offen offset:2048 sc1
    buffer_load_dwordx4 a[40:43], v1, s[44:47], s84 offen offset:3072 sc1
    s_add_u32 s84, s84, 4096
    buffer_load_dwordx4 a[72:75], v1, s[44:47], s84 offen offset:0 sc1
    buffer_load_dwordx4 a[104:107], v1, s[44:47], s84 offen offset:1024 sc1
    buffer_load_dwordx4 a[148:151], v1, s[44:47], s84 offen offset:2048 sc1
    buffer_load_dwordx4 a[180:183], v1, s[44:47], s84 offen offset:3072 sc1
    s_add_u32 s84, s84, 4096
    buffer_load_dwordx4 a[212:215], v1, s[44:47], s84 offen offset:0 sc1
    buffer_load_dwordx4 a[244:247], v1, s[44:47], s84 offen offset:1024 sc1
    buffer_load_dwordx4 a[12:15], v1, s[44:47], s84 offen offset:2048 sc1
    buffer_load_dwordx4 a[44:47], v1, s[44:47], s84 offen offset:3072 sc1
    s_add_u32 s84, s84, 4096
    buffer_load_dwordx4 a[76:79], v1, s[44:47], s84 offen offset:0 sc1
    buffer_load_dwordx4 a[108:111], v1, s[44:47], s84 offen offset:1024 sc1
    buffer_load_dwordx4 a[144:147], v1, s[44:47], s84 offen offset:2048 sc1
    buffer_load_dwordx4 a[176:179], v1, s[44:47], s84 offen offset:3072 sc1
    s_add_u32 s84, s84, 4096
    buffer_load_dwordx4 a[208:211], v1, s[44:47], s84 offen offset:0 sc1
    buffer_load_dwordx4 a[240:243], v1, s[44:47], s84 offen offset:1024 sc1
    buffer_load_dwordx4 a[16:19], v1, s[44:47], s84 offen offset:2048 sc1
    buffer_load_dwordx4 a[48:51], v1, s[44:47], s84 offen offset:3072 sc1
    s_add_u32 s84, s84, 4096
    buffer_load_dwordx4 a[80:83], v1, s[44:47], s84 offen offset:0 sc1
    buffer_load_dwordx4 a[112:115], v1, s[44:47], s84 offen offset:1024 sc1
    buffer_load_dwordx4 a[140:143], v1, s[44:47], s84 offen offset:2048 sc1
    buffer_load_dwordx4 a[172:175], v1, s[44:47], s84 offen offset:3072 sc1
    s_add_u32 s84, s84, 4096
    buffer_load_dwordx4 a[204:207], v1, s[44:47], s84 offen offset:0 sc1
    buffer_load_dwordx4 a[236:239], v1, s[44:47], s84 offen offset:1024 sc1
    buffer_load_dwordx4 a[24:27], v1, s[44:47], s84 offen offset:2048 sc1
    buffer_load_dwordx4 a[56:59], v1, s[44:47], s84 offen offset:3072 sc1
    s_add_u32 s84, s84, 4096
    buffer_load_dwordx4 a[88:91], v1, s[44:47], s84 offen offset:0 sc1
    buffer_load_dwordx4 a[120:123], v1, s[44:47], s84 offen offset:1024 sc1
    buffer_load_dwordx4 a[132:135], v1, s[44:47], s84 offen offset:2048 sc1
    buffer_load_dwordx4 a[164:167], v1, s[44:47], s84 offen offset:3072 sc1
    s_add_u32 s84, s84, 4096
    buffer_load_dwordx4 a[196:199], v1, s[44:47], s84 offen offset:0 sc1
    buffer_load_dwordx4 a[228:231], v1, s[44:47], s84 offen offset:1024 sc1
    buffer_load_dwordx4 a[20:23], v1, s[44:47], s84 offen offset:2048 sc1
    buffer_load_dwordx4 a[52:55], v1, s[44:47], s84 offen offset:3072 sc1
    s_add_u32 s84, s84, 4096
    buffer_load_dwordx4 a[84:87], v1, s[44:47], s84 offen offset:0 sc1
    buffer_load_dwordx4 a[116:119], v1, s[44:47], s84 offen offset:1024 sc1
    buffer_load_dwordx4 a[136:139], v1, s[44:47], s84 offen offset:2048 sc1
    buffer_load_dwordx4 a[168:171], v1, s[44:47], s84 offen offset:3072 sc1
    s_add_u32 s84, s84, 4096
    buffer_load_dwordx4 a[200:203], v1, s[28:31], s84 offen offset:0 sc1
    buffer_load_dwordx4 a[232:235], v1, s[28:31], s84 offen offset:1024 sc1
    buffer_load_dwordx4 a[28:31], v1, s[28:31], s84 offen offset:2048 sc1
    buffer_load_dwordx4 a[60:63], v1, s[28:31], s84 offen offset:3072 sc1
    s_add_u32 s84, s84, 4096
    buffer_load_dwordx4 a[92:95], v1, s[28:31], s84 offen offset:0 sc1
    buffer_load_dwordx4 a[124:127], v1, s[28:31], s84 offen offset:1024 sc1
    buffer_load_dwordx4 a[128:131], v1, s[28:31], s84 offen offset:2048 sc1
    buffer_load_dwordx4 a[160:163], v1, s[28:31], s84 offen offset:3072 sc1
    s_add_u32 s84, s84, 4096
    buffer_load_dwordx4 a[192:195], v1, s[28:31], s84 offen offset:0 sc1
    buffer_load_dwordx4 a[224:227], v1, s[28:31], s84 offen offset:1024 sc1
    s_setpc_b64 s[94:95]
A_LATE:
    s_mov_b32 s69, 65536
POLL_21:
    buffer_load_dword v14, v10, s[44:47], s77 offen sc1
    s_waitcnt vmcnt(0)
    v_cmp_ne_u32 vcc, s48, v14
    s_cbranch_vccz PDONE_22
    s_sub_u32 s69, s69, 1
    s_cbranch_scc0 POLL_21
PDONE_22:
    s_add_u32 m0, s82, 0
    s_nop 0
    buffer_load_dwordx4 v1, s[44:47], s79 offen offset:0 sc1 lds
    buffer_load_dwordx4 v1, s[44:47], s79 offen offset:1024 sc1 lds
    buffer_load_dwordx4 v1, s[44:47], s79 offen offset:2048 sc1 lds
    buffer_load_dwordx4 v1, s[44:47], s79 offen offset:3072 sc1 lds
    s_add_u32 m0, m0, 4096
    s_nop 0
    buffer_load_dwordx4 v6, s[44:47], s79 offen offset:0 sc1 lds
    buffer_load_dwordx4 v6, s[44:47], s79 offen offset:1024 sc1 lds
    buffer_load_dwordx4 v6, s[44:47], s79 offen offset:2048 sc1 lds
    buffer_load_dwordx4 v6, s[44:47], s79 offen offset:3072 sc1 lds
    s_add_u32 m0, m0, 4096
    s_add_u32 s91, s79, 4096
    buffer_load_dwordx4 v6, s[44:47], s91 offen offset:0 sc1 lds
    buffer_load_dwordx4 v6, s[44:47], s91 offen offset:1024 sc1 lds
    s_waitcnt vmcnt(0)
    s_setpc_b64 s[92:93]
F_RETRY:
    s_mov_b32 s69, 65536
F_RL:
    buffer_load_dwordx4 v[16:19], v2, s[44:47], s35 offen sc1
    buffer_load_dwordx4 v[20:23], v3, s[44:47], s35 offen sc1
    buffer_load_dwordx4 v[24:27], v4, s[44:47], s35 offen sc1
    buffer_load_dwordx4 v[28:31], v5, s[44:47], s35 offen sc1
    buffer_load_dwordx4 v[48:51], v6, s[44:47], s35 offen sc1
    s_waitcnt vmcnt(0)
    v_max3_u32 v64, v16, v17, v18
    v_max3_u32 v65, v26, v27, v28
    v_max3_u32 v64, v64, v19, v20
    v_max3_u32 v65, v65, v29, v30
    v_max3_u32 v64, v64, v21, v22
    v_max3_u32 v65, v65, v31, v48
    v_max3_u32 v64, v64, v23, v24
    v_max3_u32 v65, v65, v49, v50
    v_max3_u32 v64, v64, v25, v51
    v_max_u32 v64, v64, v65
    v_cmp_eq_u32 vcc, -1, v64
    s_cbranch_vccz F_OK
    s_sub_u32 s69, s69, 1
    s_cbranch_scc0 F_RL
    s_branch F_OK
Y_LATE:
    s_waitcnt vmcnt(0)
    s_mov_b64 exec, 1
    buffer_store_dword v15, off, s[44:47], s76 sc1
    s_mov_b64 exec, -1
    s_sub_u32 m0, m0, 4096
    s_sub_u32 s88, s88, 4096
Y_FIRST:
    s_mov_b32 s69, 65536
POLL_23:
    buffer_load_dword v14, v69, s[44:47], s14 offen sc1
    s_waitcnt vmcnt(0)
    v_cmp_ne_u32 vcc, s48, v14
    s_cbranch_vccz PDONE_24
    s_sub_u32 s69, s69, 1
    s_cbranch_scc0 POLL_23
PDONE_24:
    buffer_load_dwordx4 v68, s[44:47], s88 offen offset:0 sc1 lds
    buffer_load_dwordx4 v68, s[44:47], s88 offen offset:1024 sc1 lds
    buffer_load_dwordx4 v68, s[44:47], s88 offen offset:2048 sc1 lds
    buffer_load_dwordx4 v68, s[44:47], s88 offen offset:3072 sc1 lds
    s_add_u32 m0, m0, 4096
    s_add_u32 s88, s88, 4096
    buffer_load_dwordx4 v68, s[44:47], s88 offen sc1 lds
    s_waitcnt vmcnt(0)
    s_setpc_b64 s[92:93]
SPIN_5:
    s_mov_b32 s69, 65536
POLL_25:
    buffer_load_dword v14, v9, s[44:47], s73 offen sc1
    s_waitcnt vmcnt(0)
    v_cmp_ne_u32 vcc, s48, v14
    s_cbranch_vccz PDONE_26
    s_sub_u32 s69, s69, 1
    s_cbranch_scc0 POLL_25
PDONE_26:
    s_branch SRET_6
SPIN_9:
    s_mov_b32 s69, 65536
POLL_27:
    buffer_load_dword v14, v37, s[44:47], s90 offen sc1
    s_waitcnt vmcnt(0)
    v_cmp_ne_u32 vcc, s48, v14
    s_cbranch_vccz PDONE_28
    s_sub_u32 s69, s69, 1
    s_cbranch_scc0 POLL_27
PDONE_28:
    s_branch SRET_10
SPIN_11:
    s_mov_b32 s69, 65536
POLL_29:
    buffer_load_dword v14, v70, s[44:47], s89 offen sc1
    s_waitcnt vmcnt(0)
    v_cmp_ne_u32 vcc, s48, v14
    s_cbranch_vccz PDONE_30
    s_sub_u32 s69, s69, 1
    s_cbranch_scc0 POLL_29
PDONE_30:
    s_branch SRET_12
SPIN_14:
    s_mov_b32 s69, 65536
POLL_31:
    buffer_load_dword v14, v9, s[44:47], s73 offen sc1
    s_waitcnt vmcnt(0)
    v_cmp_ne_u32 vcc, s48, v14
    s_cbranch_vccz PDONE_32
    s_sub_u32 s69, s69, 1
    s_cbranch_scc0 POLL_31
PDONE_32:
    s_branch SRET_15
.section .rodata,"a"
.p2align 6
.amdhsa_kernel interleave_layers__ssm_conv_h3__geglu_ffn__prompt_kernel
  .amdhsa_next_free_vgpr 512
  .amdhsa_next_free_sgpr 102
  .amdhsa_accum_offset 256
  .amdhsa_group_segment_fixed_size 0
  .amdhsa_kernarg_size 104
  .amdhsa_user_sgpr_count 2
  .amdhsa_user_sgpr_kernarg_segment_ptr 1
  .amdhsa_system_sgpr_workgroup_id_x 1
.end_amdhsa_kernel
```
